```python
import torch

def _softmax(x, axis=-1):
    return torch.softmax(x, dim=axis)
def _gelu(x):
    return torch.nn.functional.gelu(x, approximate="tanh")
def _silu(x):
    return torch.nn.functional.silu(x)
def _sigmoid(x):
    return torch.sigmoid(x)
def _layernorm(x, axis=-1, eps=1e-5):
    m = x.mean(dim=axis, keepdim=True)
    v = x.var(dim=axis, keepdim=True, unbiased=False)
    return (x - m) / torch.sqrt(v + eps)
def _scatter_add(tgt, idx, src, axis=0):
    return tgt.clone().index_add_(axis, idx, src)
def _segment_sum(src, seg, n):
    out = torch.zeros((n,) + src.shape[1:], dtype=src.dtype)
    return out.index_add_(0, seg, src)
def _pad(x, pw):
    flat = tuple(v for pair in reversed(pw) for v in pair)
    return torch.nn.functional.pad(x, flat)

kernel_name = 'sequential_preLN__sliding_block_cached__geglu_ffn__decode'

def setup_inputs():

    _w = (lambda a: (lambda t: t.to(torch.bfloat16) if t.is_floating_point() else t)(torch.as_tensor(a)))
    def _A_setup():
        B, Sq, D = 2, 1, 640
        Hq, Hkv, Sk, Dh = 32, 32, 8192, 192
        assert Hq % Hkv == 0, (Hq, Hkv)
        return {
            "x": _w((lambda *s: torch.randn(*s, dtype=torch.bfloat16) * 0.05)(B, Sq, D)),
            "k_cache": _w((lambda *s: torch.randn(*s, dtype=torch.bfloat16) * 3.2)(B, Hkv, Sk, Dh)),
            "v_cache": _w((lambda *s: torch.randn(*s, dtype=torch.bfloat16) * 0.4)(B, Hkv, Sk, Dh)),
            "wq": _w((lambda *s: torch.randn(*s, dtype=torch.bfloat16) * 3.2)(D, Hq * Dh) * (D ** -0.5)),
            "wo": _w((lambda *s: torch.randn(*s, dtype=torch.bfloat16) * 0.4)(Hq * Dh, D) * ((Hq * Dh) ** -0.5)),
        }
    _A_in = _A_setup()

    def _B_setup():
        B, S, D, F = 2, 1, 640, 1536
        return {
            "x": _w((lambda *s: torch.randn(*s, dtype=torch.bfloat16) * 0.05)(B, S, D)),
            "w_gate": _w((lambda *s: torch.randn(*s, dtype=torch.bfloat16) * 0.05)(D, F)),
            "w_up": _w((lambda *s: torch.randn(*s, dtype=torch.bfloat16) * 0.05)(D, F)),
            "w_down": _w((lambda *s: torch.randn(*s, dtype=torch.bfloat16) * 0.05)(F, D)),
        }
    _B_in = _B_setup()

    return {
        "A_x": _A_in["x"],
        "A_k_cache": _A_in["k_cache"],
        "A_v_cache": _A_in["v_cache"],
        "A_wq": _A_in["wq"],
        "A_wo": _A_in["wo"],
        "B_x": _B_in["x"],
        "B_w_gate": _B_in["w_gate"],
        "B_w_up": _B_in["w_up"],
        "B_w_down": _B_in["w_down"],
    }

def reference(A_x, A_k_cache, A_v_cache, A_wq, A_wo, B_x, B_w_gate, B_w_up, B_w_down):
    def _A_ref(x, k_cache, v_cache, wq, wo):
        B, Sq, D = x.shape
        Hq, Dh = 32, 192
        Hkv, Sk = k_cache.shape[1], k_cache.shape[2]
        W = min(4096, max(256, Sk // 4))
        rep = Hq // Hkv
        q = (lambda x, *d: x.permute(*d))((x @ wq).reshape(B, Sq, Hq, Dh), 0, 2, 1, 3)
        k = (lambda x, n, axis: torch.repeat_interleave(x, n, dim=axis))(k_cache[:, :, Sk - W:, :], rep, axis=1)
        v = (lambda x, n, axis: torch.repeat_interleave(x, n, dim=axis))(v_cache[:, :, Sk - W:, :], rep, axis=1)
        scores = torch.einsum("bhqd,bhkd->bhqk", q, k) * (Dh ** -0.5)
        p = _softmax(scores, axis=-1)
        o = torch.einsum("bhqk,bhkd->bhqd", p, v)
        return (lambda x, *d: x.permute(*d))(o, 0, 2, 1, 3).reshape(B, Sq, Hq * Dh) @ wo

    def _B_ref(x, w_gate, w_up, w_down):
        return (_gelu(x @ w_gate) * (x @ w_up)) @ w_down

    x = A_x
    h = x + _A_ref(_layernorm(x, axis=-1), A_k_cache, A_v_cache, A_wq, A_wo)
    h2 = h + _B_ref(_layernorm(h, axis=-1), B_w_gate, B_w_up, B_w_down)
    return h2
```

```asm
; @launch kernel=kq_kernel grid=(256,1,1) block=(256,1,1) lds=17408
; @launch kernel=ka_kernel grid=(512,1,1) block=(256,1,1) lds=75776
; @launch kernel=kt_kernel grid=(276,1,1) block=(256,1,1) lds=39168
.amdgcn_target "amdgcn-amd-amdhsa--gfx950"
.text
.globl kq_kernel
.p2align 8
.type kq_kernel,@function
kq_kernel:
    s_cmp_ge_u32 s2, 256
    s_cbranch_scc1 kq_done
    s_load_dwordx2 s[8:9], s[0:1], 0
    s_load_dwordx2 s[12:13], s[0:1], 24
    s_load_dwordx2 s[16:17], s[0:1], 88
    s_waitcnt lgkmcnt(0)
    s_and_b32 s9, s9, 0xffff
    s_mov_b32 s10, 2560
    s_mov_b32 s11, 0x00020000
    s_and_b32 s13, s13, 0xffff
    s_mov_b32 s14, 7864320
    s_mov_b32 s15, 0x00020000
    s_and_b32 s17, s17, 0xffff
    s_mov_b32 s18, 805306368
    s_mov_b32 s19, 0x00020000
    v_and_b32 v1, 63, v0
    v_lshrrev_b32 v2, 6, v0
    v_lshlrev_b32 v3, 2, v1
    s_lshr_b32 s20, s2, 3
    s_and_b32 s21, s2, 7
    v_and_b32 v6, 1, v2
    v_mul_u32_u24 v7, 1280, v6
    v_add_u32 v7, v7, v3
    buffer_load_dword v8, v7, s[8:11], 0 offen offset:0
    buffer_load_dword v9, v7, s[8:11], 0 offen offset:256
    buffer_load_dword v10, v7, s[8:11], 0 offen offset:512
    buffer_load_dword v11, v7, s[8:11], 0 offen offset:768
    buffer_load_dword v12, v7, s[8:11], 0 offen offset:1024
    v_lshrrev_b32 v28, 5, v1
    v_and_b32 v29, 31, v1
    v_lshl_add_u32 v30, v2, 1, v28
    v_mul_u32_u24 v31, 12288, v30
    v_mul_u32_u24 v27, 12, v29
    v_add_u32 v31, v31, v27
    s_mul_i32 s22, s20, 384
    s_mul_i32 s23, s21, 983040
    s_add_u32 s22, s22, s23
    buffer_load_dwordx3 v[32:34], v31, s[12:15], s22 offen nt
    s_add_u32 s22, s22, 98304
    buffer_load_dwordx3 v[36:38], v31, s[12:15], s22 offen nt
    s_add_u32 s22, s22, 98304
    buffer_load_dwordx3 v[40:42], v31, s[12:15], s22 offen nt
    s_add_u32 s22, s22, 98304
    buffer_load_dwordx3 v[44:46], v31, s[12:15], s22 offen nt
    s_add_u32 s22, s22, 98304
    buffer_load_dwordx3 v[48:50], v31, s[12:15], s22 offen nt
    s_add_u32 s22, s22, 98304
    buffer_load_dwordx3 v[52:54], v31, s[12:15], s22 offen nt
    s_add_u32 s22, s22, 98304
    buffer_load_dwordx3 v[56:58], v31, s[12:15], s22 offen nt
    s_add_u32 s22, s22, 98304
    buffer_load_dwordx3 v[60:62], v31, s[12:15], s22 offen nt
    s_add_u32 s22, s22, 98304
    buffer_load_dwordx3 v[64:66], v31, s[12:15], s22 offen nt
    s_add_u32 s22, s22, 98304
    buffer_load_dwordx3 v[68:70], v31, s[12:15], s22 offen nt
    v_mov_b32 v92, -1
    v_mov_b32 v93, -1
    v_mov_b32 v94, -1
    v_mov_b32 v95, -1
    v_lshlrev_b32 v96, 4, v0
    s_mul_i32 s23, s2, 2100
    s_add_u32 s23, s23, 1048576
    v_cmp_gt_u32 vcc, 132, v0
    s_and_saveexec_b64 s[24:25], vcc
    s_cbranch_execz kq_nofill
    buffer_store_dwordx4 v[92:95], v96, s[16:19], s23 offen
kq_nofill:
    s_mov_b64 exec, s[24:25]
    s_waitcnt vmcnt(10)
    v_lshlrev_b32 v14, 16, v8
    v_and_b32 v15, 0xffff0000, v8
    v_lshlrev_b32 v16, 16, v9
    v_and_b32 v17, 0xffff0000, v9
    v_lshlrev_b32 v18, 16, v10
    v_and_b32 v19, 0xffff0000, v10
    v_lshlrev_b32 v20, 16, v11
    v_and_b32 v21, 0xffff0000, v11
    v_lshlrev_b32 v22, 16, v12
    v_and_b32 v23, 0xffff0000, v12
    v_add_f32 v24, v14, v15
    v_add_f32 v24, v24, v16
    v_add_f32 v24, v24, v17
    v_add_f32 v24, v24, v18
    v_add_f32 v24, v24, v19
    v_add_f32 v24, v24, v20
    v_add_f32 v24, v24, v21
    v_add_f32 v24, v24, v22
    v_add_f32 v24, v24, v23
    s_nop 1
    v_add_f32_dpp v24, v24, v24 row_ror:1 row_mask:0xf bank_mask:0xf
    s_nop 1
    v_add_f32_dpp v24, v24, v24 row_ror:2 row_mask:0xf bank_mask:0xf
    s_nop 1
    v_add_f32_dpp v24, v24, v24 row_ror:4 row_mask:0xf bank_mask:0xf
    s_nop 1
    v_add_f32_dpp v24, v24, v24 row_ror:8 row_mask:0xf bank_mask:0xf
    s_nop 0
    v_readlane_b32 s40, v24, 0
    v_readlane_b32 s41, v24, 16
    v_readlane_b32 s42, v24, 32
    v_readlane_b32 s43, v24, 48
    s_nop 1
    v_mov_b32 v24, s40
    v_add_f32 v24, s41, v24
    v_add_f32 v24, s42, v24
    v_add_f32 v24, s43, v24
    v_mul_f32 v24, 0.0015625, v24
    v_sub_f32 v26, v14, v24
    v_mul_f32 v25, v26, v26
    v_sub_f32 v26, v15, v24
    v_fmac_f32 v25, v26, v26
    v_sub_f32 v26, v16, v24
    v_fmac_f32 v25, v26, v26
    v_sub_f32 v26, v17, v24
    v_fmac_f32 v25, v26, v26
    v_sub_f32 v26, v18, v24
    v_fmac_f32 v25, v26, v26
    v_sub_f32 v26, v19, v24
    v_fmac_f32 v25, v26, v26
    v_sub_f32 v26, v20, v24
    v_fmac_f32 v25, v26, v26
    v_sub_f32 v26, v21, v24
    v_fmac_f32 v25, v26, v26
    v_sub_f32 v26, v22, v24
    v_fmac_f32 v25, v26, v26
    v_sub_f32 v26, v23, v24
    v_fmac_f32 v25, v26, v26
    s_nop 1
    v_add_f32_dpp v25, v25, v25 row_ror:1 row_mask:0xf bank_mask:0xf
    s_nop 1
    v_add_f32_dpp v25, v25, v25 row_ror:2 row_mask:0xf bank_mask:0xf
    s_nop 1
    v_add_f32_dpp v25, v25, v25 row_ror:4 row_mask:0xf bank_mask:0xf
    s_nop 1
    v_add_f32_dpp v25, v25, v25 row_ror:8 row_mask:0xf bank_mask:0xf
    s_nop 0
    v_readlane_b32 s40, v25, 0
    v_readlane_b32 s41, v25, 16
    v_readlane_b32 s42, v25, 32
    v_readlane_b32 s43, v25, 48
    s_nop 1
    v_mov_b32 v25, s40
    v_add_f32 v25, s41, v25
    v_add_f32 v25, s42, v25
    v_add_f32 v25, s43, v25
    v_mul_f32 v25, 0.0015625, v25
    v_cvt_pk_bf16_f32 v24, v24, v24
    v_lshlrev_b32 v24, 16, v24
    v_cvt_pk_bf16_f32 v25, v25, v25
    v_lshlrev_b32 v25, 16, v25
    v_add_f32 v25, 1e-05, v25
    v_cvt_pk_bf16_f32 v25, v25, v25
    v_lshlrev_b32 v25, 16, v25
    v_sqrt_f32 v25, v25
    s_nop 0
    v_cvt_pk_bf16_f32 v25, v25, v25
    v_lshlrev_b32 v25, 16, v25
    v_rcp_f32 v25, v25
    s_nop 0
    v_sub_f32 v14, v14, v24
    v_cvt_pk_bf16_f32 v14, v14, v14
    v_lshlrev_b32 v14, 16, v14
    v_mul_f32 v14, v14, v25
    v_cvt_pk_bf16_f32 v14, v14, v14
    v_lshlrev_b32 v14, 16, v14
    v_sub_f32 v15, v15, v24
    v_cvt_pk_bf16_f32 v15, v15, v15
    v_lshlrev_b32 v15, 16, v15
    v_mul_f32 v15, v15, v25
    v_cvt_pk_bf16_f32 v15, v15, v15
    v_lshlrev_b32 v15, 16, v15
    v_sub_f32 v16, v16, v24
    v_cvt_pk_bf16_f32 v16, v16, v16
    v_lshlrev_b32 v16, 16, v16
    v_mul_f32 v16, v16, v25
    v_cvt_pk_bf16_f32 v16, v16, v16
    v_lshlrev_b32 v16, 16, v16
    v_sub_f32 v17, v17, v24
    v_cvt_pk_bf16_f32 v17, v17, v17
    v_lshlrev_b32 v17, 16, v17
    v_mul_f32 v17, v17, v25
    v_cvt_pk_bf16_f32 v17, v17, v17
    v_lshlrev_b32 v17, 16, v17
    v_sub_f32 v18, v18, v24
    v_cvt_pk_bf16_f32 v18, v18, v18
    v_lshlrev_b32 v18, 16, v18
    v_mul_f32 v18, v18, v25
    v_cvt_pk_bf16_f32 v18, v18, v18
    v_lshlrev_b32 v18, 16, v18
    v_sub_f32 v19, v19, v24
    v_cvt_pk_bf16_f32 v19, v19, v19
    v_lshlrev_b32 v19, 16, v19
    v_mul_f32 v19, v19, v25
    v_cvt_pk_bf16_f32 v19, v19, v19
    v_lshlrev_b32 v19, 16, v19
    v_sub_f32 v20, v20, v24
    v_cvt_pk_bf16_f32 v20, v20, v20
    v_lshlrev_b32 v20, 16, v20
    v_mul_f32 v20, v20, v25
    v_cvt_pk_bf16_f32 v20, v20, v20
    v_lshlrev_b32 v20, 16, v20
    v_sub_f32 v21, v21, v24
    v_cvt_pk_bf16_f32 v21, v21, v21
    v_lshlrev_b32 v21, 16, v21
    v_mul_f32 v21, v21, v25
    v_cvt_pk_bf16_f32 v21, v21, v21
    v_lshlrev_b32 v21, 16, v21
    v_sub_f32 v22, v22, v24
    v_cvt_pk_bf16_f32 v22, v22, v22
    v_lshlrev_b32 v22, 16, v22
    v_mul_f32 v22, v22, v25
    v_cvt_pk_bf16_f32 v22, v22, v22
    v_lshlrev_b32 v22, 16, v22
    v_sub_f32 v23, v23, v24
    v_cvt_pk_bf16_f32 v23, v23, v23
    v_lshlrev_b32 v23, 16, v23
    v_mul_f32 v23, v23, v25
    v_cvt_pk_bf16_f32 v23, v23, v23
    v_lshlrev_b32 v23, 16, v23
    v_lshlrev_b32 v24, 4, v1
    v_lshl_add_u32 v24, v6, 2, v24
    ds_write_b32 v24, v14 offset:0
    ds_write_b32 v24, v15 offset:8
    ds_write_b32 v24, v16 offset:1024
    ds_write_b32 v24, v17 offset:1032
    ds_write_b32 v24, v18 offset:2048
    ds_write_b32 v24, v19 offset:2056
    ds_write_b32 v24, v20 offset:3072
    ds_write_b32 v24, v21 offset:3080
    ds_write_b32 v24, v22 offset:4096
    ds_write_b32 v24, v23 offset:4104
    s_waitcnt lgkmcnt(0)
    s_barrier
    s_mul_i32 s23, s21, 640
    v_lshlrev_b32 v24, 3, v30
    v_add_u32 v24, s23, v24
    ds_read_b64 v[72:73], v24 offset:0
    ds_read_b64 v[74:75], v24 offset:64
    ds_read_b64 v[76:77], v24 offset:128
    ds_read_b64 v[78:79], v24 offset:192
    ds_read_b64 v[80:81], v24 offset:256
    ds_read_b64 v[82:83], v24 offset:320
    ds_read_b64 v[84:85], v24 offset:384
    ds_read_b64 v[86:87], v24 offset:448
    ds_read_b64 v[88:89], v24 offset:512
    ds_read_b64 v[90:91], v24 offset:576
    v_mov_b32 v92, 0
    v_mov_b32 v93, 0
    v_mov_b32 v94, 0
    v_mov_b32 v95, 0
    v_mov_b32 v96, 0
    v_mov_b32 v97, 0
    v_mov_b32 v98, 0
    v_mov_b32 v99, 0
    v_mov_b32 v100, 0
    v_mov_b32 v101, 0
    v_mov_b32 v102, 0
    v_mov_b32 v103, 0
    s_waitcnt lgkmcnt(0)
    s_waitcnt vmcnt(9)
    v_lshlrev_b32 v4, 16, v32
    v_and_b32 v5, 0xffff0000, v32
    v_fmac_f32 v92, v72, v4
    v_fmac_f32 v93, v72, v5
    v_fmac_f32 v98, v73, v4
    v_fmac_f32 v99, v73, v5
    v_lshlrev_b32 v4, 16, v33
    v_and_b32 v5, 0xffff0000, v33
    v_fmac_f32 v94, v72, v4
    v_fmac_f32 v95, v72, v5
    v_fmac_f32 v100, v73, v4
    v_fmac_f32 v101, v73, v5
    v_lshlrev_b32 v4, 16, v34
    v_and_b32 v5, 0xffff0000, v34
    v_fmac_f32 v96, v72, v4
    v_fmac_f32 v97, v72, v5
    v_fmac_f32 v102, v73, v4
    v_fmac_f32 v103, v73, v5
    s_waitcnt vmcnt(8)
    v_lshlrev_b32 v4, 16, v36
    v_and_b32 v5, 0xffff0000, v36
    v_fmac_f32 v92, v74, v4
    v_fmac_f32 v93, v74, v5
    v_fmac_f32 v98, v75, v4
    v_fmac_f32 v99, v75, v5
    v_lshlrev_b32 v4, 16, v37
    v_and_b32 v5, 0xffff0000, v37
    v_fmac_f32 v94, v74, v4
    v_fmac_f32 v95, v74, v5
    v_fmac_f32 v100, v75, v4
    v_fmac_f32 v101, v75, v5
    v_lshlrev_b32 v4, 16, v38
    v_and_b32 v5, 0xffff0000, v38
    v_fmac_f32 v96, v74, v4
    v_fmac_f32 v97, v74, v5
    v_fmac_f32 v102, v75, v4
    v_fmac_f32 v103, v75, v5
    s_waitcnt vmcnt(7)
    v_lshlrev_b32 v4, 16, v40
    v_and_b32 v5, 0xffff0000, v40
    v_fmac_f32 v92, v76, v4
    v_fmac_f32 v93, v76, v5
    v_fmac_f32 v98, v77, v4
    v_fmac_f32 v99, v77, v5
    v_lshlrev_b32 v4, 16, v41
    v_and_b32 v5, 0xffff0000, v41
    v_fmac_f32 v94, v76, v4
    v_fmac_f32 v95, v76, v5
    v_fmac_f32 v100, v77, v4
    v_fmac_f32 v101, v77, v5
    v_lshlrev_b32 v4, 16, v42
    v_and_b32 v5, 0xffff0000, v42
    v_fmac_f32 v96, v76, v4
    v_fmac_f32 v97, v76, v5
    v_fmac_f32 v102, v77, v4
    v_fmac_f32 v103, v77, v5
    s_waitcnt vmcnt(6)
    v_lshlrev_b32 v4, 16, v44
    v_and_b32 v5, 0xffff0000, v44
    v_fmac_f32 v92, v78, v4
    v_fmac_f32 v93, v78, v5
    v_fmac_f32 v98, v79, v4
    v_fmac_f32 v99, v79, v5
    v_lshlrev_b32 v4, 16, v45
    v_and_b32 v5, 0xffff0000, v45
    v_fmac_f32 v94, v78, v4
    v_fmac_f32 v95, v78, v5
    v_fmac_f32 v100, v79, v4
    v_fmac_f32 v101, v79, v5
    v_lshlrev_b32 v4, 16, v46
    v_and_b32 v5, 0xffff0000, v46
    v_fmac_f32 v96, v78, v4
    v_fmac_f32 v97, v78, v5
    v_fmac_f32 v102, v79, v4
    v_fmac_f32 v103, v79, v5
    s_waitcnt vmcnt(5)
    v_lshlrev_b32 v4, 16, v48
    v_and_b32 v5, 0xffff0000, v48
    v_fmac_f32 v92, v80, v4
    v_fmac_f32 v93, v80, v5
    v_fmac_f32 v98, v81, v4
    v_fmac_f32 v99, v81, v5
    v_lshlrev_b32 v4, 16, v49
    v_and_b32 v5, 0xffff0000, v49
    v_fmac_f32 v94, v80, v4
    v_fmac_f32 v95, v80, v5
    v_fmac_f32 v100, v81, v4
    v_fmac_f32 v101, v81, v5
    v_lshlrev_b32 v4, 16, v50
    v_and_b32 v5, 0xffff0000, v50
    v_fmac_f32 v96, v80, v4
    v_fmac_f32 v97, v80, v5
    v_fmac_f32 v102, v81, v4
    v_fmac_f32 v103, v81, v5
    s_waitcnt vmcnt(4)
    v_lshlrev_b32 v4, 16, v52
    v_and_b32 v5, 0xffff0000, v52
    v_fmac_f32 v92, v82, v4
    v_fmac_f32 v93, v82, v5
    v_fmac_f32 v98, v83, v4
    v_fmac_f32 v99, v83, v5
    v_lshlrev_b32 v4, 16, v53
    v_and_b32 v5, 0xffff0000, v53
    v_fmac_f32 v94, v82, v4
    v_fmac_f32 v95, v82, v5
    v_fmac_f32 v100, v83, v4
    v_fmac_f32 v101, v83, v5
    v_lshlrev_b32 v4, 16, v54
    v_and_b32 v5, 0xffff0000, v54
    v_fmac_f32 v96, v82, v4
    v_fmac_f32 v97, v82, v5
    v_fmac_f32 v102, v83, v4
    v_fmac_f32 v103, v83, v5
    s_waitcnt vmcnt(3)
    v_lshlrev_b32 v4, 16, v56
    v_and_b32 v5, 0xffff0000, v56
    v_fmac_f32 v92, v84, v4
    v_fmac_f32 v93, v84, v5
    v_fmac_f32 v98, v85, v4
    v_fmac_f32 v99, v85, v5
    v_lshlrev_b32 v4, 16, v57
    v_and_b32 v5, 0xffff0000, v57
    v_fmac_f32 v94, v84, v4
    v_fmac_f32 v95, v84, v5
    v_fmac_f32 v100, v85, v4
    v_fmac_f32 v101, v85, v5
    v_lshlrev_b32 v4, 16, v58
    v_and_b32 v5, 0xffff0000, v58
    v_fmac_f32 v96, v84, v4
    v_fmac_f32 v97, v84, v5
    v_fmac_f32 v102, v85, v4
    v_fmac_f32 v103, v85, v5
    s_waitcnt vmcnt(2)
    v_lshlrev_b32 v4, 16, v60
    v_and_b32 v5, 0xffff0000, v60
    v_fmac_f32 v92, v86, v4
    v_fmac_f32 v93, v86, v5
    v_fmac_f32 v98, v87, v4
    v_fmac_f32 v99, v87, v5
    v_lshlrev_b32 v4, 16, v61
    v_and_b32 v5, 0xffff0000, v61
    v_fmac_f32 v94, v86, v4
    v_fmac_f32 v95, v86, v5
    v_fmac_f32 v100, v87, v4
    v_fmac_f32 v101, v87, v5
    v_lshlrev_b32 v4, 16, v62
    v_and_b32 v5, 0xffff0000, v62
    v_fmac_f32 v96, v86, v4
    v_fmac_f32 v97, v86, v5
    v_fmac_f32 v102, v87, v4
    v_fmac_f32 v103, v87, v5
    s_waitcnt vmcnt(1)
    v_lshlrev_b32 v4, 16, v64
    v_and_b32 v5, 0xffff0000, v64
    v_fmac_f32 v92, v88, v4
    v_fmac_f32 v93, v88, v5
    v_fmac_f32 v98, v89, v4
    v_fmac_f32 v99, v89, v5
    v_lshlrev_b32 v4, 16, v65
    v_and_b32 v5, 0xffff0000, v65
    v_fmac_f32 v94, v88, v4
    v_fmac_f32 v95, v88, v5
    v_fmac_f32 v100, v89, v4
    v_fmac_f32 v101, v89, v5
    v_lshlrev_b32 v4, 16, v66
    v_and_b32 v5, 0xffff0000, v66
    v_fmac_f32 v96, v88, v4
    v_fmac_f32 v97, v88, v5
    v_fmac_f32 v102, v89, v4
    v_fmac_f32 v103, v89, v5
    s_waitcnt vmcnt(0)
    v_lshlrev_b32 v4, 16, v68
    v_and_b32 v5, 0xffff0000, v68
    v_fmac_f32 v92, v90, v4
    v_fmac_f32 v93, v90, v5
    v_fmac_f32 v98, v91, v4
    v_fmac_f32 v99, v91, v5
    v_lshlrev_b32 v4, 16, v69
    v_and_b32 v5, 0xffff0000, v69
    v_fmac_f32 v94, v90, v4
    v_fmac_f32 v95, v90, v5
    v_fmac_f32 v100, v91, v4
    v_fmac_f32 v101, v91, v5
    v_lshlrev_b32 v4, 16, v70
    v_and_b32 v5, 0xffff0000, v70
    v_fmac_f32 v96, v90, v4
    v_fmac_f32 v97, v90, v5
    v_fmac_f32 v102, v91, v4
    v_fmac_f32 v103, v91, v5
    v_mul_u32_u24 v24, 1536, v30
    v_mul_u32_u24 v25, 24, v29
    v_add_u32 v24, v24, v25
    ds_write_b64 v24, v[92:93] offset:5120
    ds_write_b64 v24, v[94:95] offset:5128
    ds_write_b64 v24, v[96:97] offset:5136
    ds_write_b64 v24, v[98:99] offset:5888
    ds_write_b64 v24, v[100:101] offset:5896
    ds_write_b64 v24, v[102:103] offset:5904
    s_waitcnt lgkmcnt(0)
    s_barrier
    v_lshlrev_b32 v24, 2, v0
    s_mul_i32 s22, s2, 1536
    s_add_u32 s22, s22, 4194304
    ds_read_b32 v32, v24 offset:5120
    ds_read_b32 v33, v24 offset:6656
    ds_read_b32 v34, v24 offset:8192
    ds_read_b32 v35, v24 offset:9728
    ds_read_b32 v36, v24 offset:11264
    ds_read_b32 v37, v24 offset:12800
    ds_read_b32 v38, v24 offset:14336
    ds_read_b32 v39, v24 offset:15872
    s_waitcnt lgkmcnt(0)
    v_add_f32 v32, v32, v33
    v_add_f32 v32, v32, v34
    v_add_f32 v32, v32, v35
    v_add_f32 v32, v32, v36
    v_add_f32 v32, v32, v37
    v_add_f32 v32, v32, v38
    v_add_f32 v32, v32, v39
    buffer_store_dword v32, v24, s[16:19], s22 offen offset:0
    v_cmp_gt_u32 vcc, 128, v0
    s_and_saveexec_b64 s[24:25], vcc
    s_cbranch_execz kq_done
    ds_read_b32 v32, v24 offset:6144
    ds_read_b32 v33, v24 offset:7680
    ds_read_b32 v34, v24 offset:9216
    ds_read_b32 v35, v24 offset:10752
    ds_read_b32 v36, v24 offset:12288
    ds_read_b32 v37, v24 offset:13824
    ds_read_b32 v38, v24 offset:15360
    ds_read_b32 v39, v24 offset:16896
    s_waitcnt lgkmcnt(0)
    v_add_f32 v32, v32, v33
    v_add_f32 v32, v32, v34
    v_add_f32 v32, v32, v35
    v_add_f32 v32, v32, v36
    v_add_f32 v32, v32, v37
    v_add_f32 v32, v32, v38
    v_add_f32 v32, v32, v39
    buffer_store_dword v32, v24, s[16:19], s22 offen offset:1024
kq_done:
    s_endpgm
.globl ka_kernel
.p2align 8
.type ka_kernel,@function
ka_kernel:
    s_cmp_ge_u32 s2, 512
    s_cbranch_scc1 ka_done
    s_load_dwordx2 s[8:9], s[0:1], 8
    s_load_dwordx2 s[12:13], s[0:1], 16
    s_load_dwordx2 s[16:17], s[0:1], 88
    s_waitcnt lgkmcnt(0)
    s_and_b32 s9, s9, 0xffff
    s_mov_b32 s10, 201326592
    s_mov_b32 s11, 0x00020000
    s_and_b32 s13, s13, 0xffff
    s_mov_b32 s14, 201326592
    s_mov_b32 s15, 0x00020000
    s_and_b32 s17, s17, 0xffff
    s_mov_b32 s18, 805306368
    s_mov_b32 s19, 0x00020000
    v_and_b32 v1, 63, v0
    v_lshrrev_b32 v2, 6, v0
    v_lshlrev_b32 v3, 2, v1
    v_and_b32 v6, 15, v1
    v_lshrrev_b32 v7, 4, v1
    v_readfirstlane_b32 s33, v2
    s_lshr_b32 s35, s2, 8
    s_and_b32 s2, s2, 255
    s_and_b32 s20, s2, 7
    s_lshl_b32 s20, s20, 2
    s_lshr_b32 s21, s2, 3
    s_and_b32 s22, s21, 3
    s_add_u32 s20, s20, s22
    s_lshr_b32 s21, s2, 5
    s_mov_b32 s22, s35
    s_mov_b32 s23, s33
    s_mul_i32 s30, s20, 12288
    s_mul_i32 s31, s22, 768
    s_add_u32 s30, s30, s31
    s_add_u32 s30, s30, 4194304
    buffer_load_dword v96, v3, s[16:19], s30 offen offset:0
    buffer_load_dword v97, v3, s[16:19], s30 offen offset:256
    buffer_load_dword v98, v3, s[16:19], s30 offen offset:512
    s_add_u32 s30, s30, 1536
    buffer_load_dword v99, v3, s[16:19], s30 offen offset:0
    buffer_load_dword v100, v3, s[16:19], s30 offen offset:256
    buffer_load_dword v101, v3, s[16:19], s30 offen offset:512
    s_add_u32 s30, s30, 1536
    buffer_load_dword v102, v3, s[16:19], s30 offen offset:0
    buffer_load_dword v103, v3, s[16:19], s30 offen offset:256
    buffer_load_dword v104, v3, s[16:19], s30 offen offset:512
    s_add_u32 s30, s30, 1536
    buffer_load_dword v105, v3, s[16:19], s30 offen offset:0
    buffer_load_dword v106, v3, s[16:19], s30 offen offset:256
    buffer_load_dword v107, v3, s[16:19], s30 offen offset:512
    s_add_u32 s30, s30, 1536
    buffer_load_dword v108, v3, s[16:19], s30 offen offset:0
    buffer_load_dword v109, v3, s[16:19], s30 offen offset:256
    buffer_load_dword v110, v3, s[16:19], s30 offen offset:512
    s_add_u32 s30, s30, 1536
    buffer_load_dword v111, v3, s[16:19], s30 offen offset:0
    buffer_load_dword v112, v3, s[16:19], s30 offen offset:256
    buffer_load_dword v113, v3, s[16:19], s30 offen offset:512
    s_add_u32 s30, s30, 1536
    buffer_load_dword v114, v3, s[16:19], s30 offen offset:0
    buffer_load_dword v115, v3, s[16:19], s30 offen offset:256
    buffer_load_dword v116, v3, s[16:19], s30 offen offset:512
    s_add_u32 s30, s30, 1536
    buffer_load_dword v117, v3, s[16:19], s30 offen offset:0
    buffer_load_dword v118, v3, s[16:19], s30 offen offset:256
    buffer_load_dword v119, v3, s[16:19], s30 offen offset:512
    v_add_u32 v10, 0, v1
    v_mul_u32_u24 v11, 2731, v10
    v_lshrrev_b32 v11, 16, v11
    v_mul_u32_u24 v12, 24, v11
    v_sub_u32 v13, v10, v12
    v_lshrrev_b32 v11, 1, v11
    v_and_b32 v11, 3, v11
    v_lshlrev_b32 v11, 1, v11
    v_xor_b32 v13, v13, v11
    v_add_u32 v13, v13, v12
    v_add_u32 v13, 64, v13
    v_lshlrev_b32 v16, 4, v13
    v_add_u32 v10, 64, v1
    v_mul_u32_u24 v11, 2731, v10
    v_lshrrev_b32 v11, 16, v11
    v_mul_u32_u24 v12, 24, v11
    v_sub_u32 v13, v10, v12
    v_lshrrev_b32 v11, 1, v11
    v_and_b32 v11, 3, v11
    v_lshlrev_b32 v11, 1, v11
    v_xor_b32 v13, v13, v11
    v_add_u32 v13, v13, v12
    v_subrev_u32 v13, 0, v13
    v_lshlrev_b32 v17, 4, v13
    v_add_u32 v10, 128, v1
    v_mul_u32_u24 v11, 2731, v10
    v_lshrrev_b32 v11, 16, v11
    v_mul_u32_u24 v12, 24, v11
    v_sub_u32 v13, v10, v12
    v_lshrrev_b32 v11, 1, v11
    v_and_b32 v11, 3, v11
    v_lshlrev_b32 v11, 1, v11
    v_xor_b32 v13, v13, v11
    v_add_u32 v13, v13, v12
    v_subrev_u32 v13, 64, v13
    v_lshlrev_b32 v18, 4, v13
    v_add_u32 v10, 192, v1
    v_mul_u32_u24 v11, 2731, v10
    v_lshrrev_b32 v11, 16, v11
    v_mul_u32_u24 v12, 24, v11
    v_sub_u32 v13, v10, v12
    v_lshrrev_b32 v11, 1, v11
    v_and_b32 v11, 3, v11
    v_lshlrev_b32 v11, 1, v11
    v_xor_b32 v13, v13, v11
    v_add_u32 v13, v13, v12
    v_subrev_u32 v13, 128, v13
    v_lshlrev_b32 v19, 4, v13
    v_add_u32 v10, 256, v1
    v_mul_u32_u24 v11, 2731, v10
    v_lshrrev_b32 v11, 16, v11
    v_mul_u32_u24 v12, 24, v11
    v_sub_u32 v13, v10, v12
    v_lshrrev_b32 v11, 1, v11
    v_and_b32 v11, 3, v11
    v_lshlrev_b32 v11, 1, v11
    v_xor_b32 v13, v13, v11
    v_add_u32 v13, v13, v12
    v_subrev_u32 v13, 192, v13
    v_lshlrev_b32 v20, 4, v13
    v_add_u32 v10, 320, v1
    v_mul_u32_u24 v11, 2731, v10
    v_lshrrev_b32 v11, 16, v11
    v_mul_u32_u24 v12, 24, v11
    v_sub_u32 v13, v10, v12
    v_lshrrev_b32 v11, 1, v11
    v_and_b32 v11, 3, v11
    v_lshlrev_b32 v11, 1, v11
    v_xor_b32 v13, v13, v11
    v_add_u32 v13, v13, v12
    v_subrev_u32 v13, 256, v13
    v_lshlrev_b32 v21, 4, v13
    s_lshl_b32 s27, s22, 5
    s_add_u32 s27, s27, s20
    s_mul_i32 s24, s27, 3145728
    s_mul_i32 s25, s21, 98304
    s_add_u32 s24, s24, s25
    s_mul_i32 s25, s23, 24576
    s_add_u32 s24, s24, s25
    s_add_u32 s24, s24, 2358272
    s_mul_i32 s34, s33, 18432
    s_add_u32 s26, s34, 0
    s_mov_b32 m0, s26
    s_add_u32 s25, s24, 0
    buffer_load_dwordx4 v16, s[8:11], s25 offen offset:0 nt lds
    buffer_load_dwordx4 v17, s[8:11], s25 offen offset:1024 nt lds
    buffer_load_dwordx4 v18, s[8:11], s25 offen offset:2048 nt lds
    buffer_load_dwordx4 v19, s[8:11], s25 offen offset:3072 nt lds
    s_add_u32 s26, s34, 4096
    s_mov_b32 m0, s26
    s_add_u32 s25, s24, 4096
    buffer_load_dwordx4 v20, s[8:11], s25 offen offset:0 nt lds
    buffer_load_dwordx4 v21, s[8:11], s25 offen offset:1024 nt lds
    s_add_u32 s26, s34, 6144
    s_mov_b32 m0, s26
    s_add_u32 s25, s24, 6144
    buffer_load_dwordx4 v16, s[8:11], s25 offen offset:0 nt lds
    buffer_load_dwordx4 v17, s[8:11], s25 offen offset:1024 nt lds
    buffer_load_dwordx4 v18, s[8:11], s25 offen offset:2048 nt lds
    buffer_load_dwordx4 v19, s[8:11], s25 offen offset:3072 nt lds
    s_add_u32 s26, s34, 10240
    s_mov_b32 m0, s26
    s_add_u32 s25, s24, 10240
    buffer_load_dwordx4 v20, s[8:11], s25 offen offset:0 nt lds
    buffer_load_dwordx4 v21, s[8:11], s25 offen offset:1024 nt lds
    s_add_u32 s26, s34, 12288
    s_mov_b32 m0, s26
    s_add_u32 s25, s24, 12288
    buffer_load_dwordx4 v16, s[8:11], s25 offen offset:0 nt lds
    buffer_load_dwordx4 v17, s[8:11], s25 offen offset:1024 nt lds
    buffer_load_dwordx4 v18, s[8:11], s25 offen offset:2048 nt lds
    buffer_load_dwordx4 v19, s[8:11], s25 offen offset:3072 nt lds
    s_add_u32 s26, s34, 16384
    s_mov_b32 m0, s26
    s_add_u32 s25, s24, 16384
    buffer_load_dwordx4 v20, s[8:11], s25 offen offset:0 nt lds
    buffer_load_dwordx4 v21, s[8:11], s25 offen offset:1024 nt lds
    v_mul_u32_u24 v15, 18432, v2
    v_lshrrev_b32 v22, 1, v6
    v_and_b32 v22, 3, v22
    v_lshlrev_b32 v22, 1, v22
    v_mul_u32_u24 v23, 24, v6
    v_add_u32 v30, 0, v7
    v_xor_b32 v30, v30, v22
    v_add_u32 v30, v30, v23
    v_lshl_add_u32 v24, v30, 4, v15
    v_add_u32 v30, 4, v7
    v_xor_b32 v30, v30, v22
    v_add_u32 v30, v30, v23
    v_lshl_add_u32 v25, v30, 4, v15
    v_add_u32 v30, 8, v7
    v_xor_b32 v30, v30, v22
    v_add_u32 v30, v30, v23
    v_lshl_add_u32 v26, v30, 4, v15
    v_add_u32 v30, 12, v7
    v_xor_b32 v30, v30, v22
    v_add_u32 v30, v30, v23
    v_lshl_add_u32 v27, v30, 4, v15
    v_add_u32 v30, 16, v7
    v_xor_b32 v30, v30, v22
    v_add_u32 v30, v30, v23
    v_lshl_add_u32 v28, v30, 4, v15
    v_add_u32 v30, 20, v7
    v_xor_b32 v30, v30, v22
    v_add_u32 v30, v30, v23
    v_lshl_add_u32 v29, v30, 4, v15
    v_lshrrev_b32 v10, 2, v6
    v_and_b32 v11, 3, v6
    v_and_b32 v12, 1, v7
    v_lshrrev_b32 v13, 1, v7
    v_mul_u32_u24 v14, 6144, v13
    v_add_u32 v14, v14, v15
    v_lshl_add_u32 v14, v11, 3, v14
    v_lshlrev_b32 v30, 3, v12
    v_add_u32 v30, 0, v30
    v_add_u32 v30, v30, v10
    v_lshrrev_b32 v31, 1, v30
    v_and_b32 v31, 3, v31
    v_mul_u32_u24 v30, 384, v30
    v_add_u32 v30, v30, v14
    v_xor_b32 v40, 0, v31
    v_lshl_add_u32 v32, v40, 5, v30
    v_xor_b32 v40, 1, v31
    v_lshl_add_u32 v33, v40, 5, v30
    v_xor_b32 v40, 2, v31
    v_lshl_add_u32 v34, v40, 5, v30
    v_xor_b32 v40, 3, v31
    v_lshl_add_u32 v35, v40, 5, v30
    v_lshlrev_b32 v30, 3, v12
    v_add_u32 v30, 4, v30
    v_add_u32 v30, v30, v10
    v_lshrrev_b32 v31, 1, v30
    v_and_b32 v31, 3, v31
    v_mul_u32_u24 v30, 384, v30
    v_add_u32 v30, v30, v14
    v_xor_b32 v40, 0, v31
    v_lshl_add_u32 v36, v40, 5, v30
    v_xor_b32 v40, 1, v31
    v_lshl_add_u32 v37, v40, 5, v30
    v_xor_b32 v40, 2, v31
    v_lshl_add_u32 v38, v40, 5, v30
    v_xor_b32 v40, 3, v31
    v_lshl_add_u32 v39, v40, 5, v30
    s_mov_b32 s28, 0x3d93cd3a
    s_mov_b32 s29, 0x3fb8aa3b
    v_lshlrev_b32 v41, 9, v2
    v_add_u32 v41, 73728, v41
    v_lshl_add_u32 v42, v1, 1, v41
    v_lshl_add_u32 v43, v7, 4, v41
    s_waitcnt vmcnt(18)
    v_add_f32 v96, v96, v99
    v_add_f32 v96, v96, v102
    v_add_f32 v96, v96, v105
    v_add_f32 v96, v96, v108
    v_add_f32 v96, v96, v111
    v_add_f32 v96, v96, v114
    v_add_f32 v96, v96, v117
    v_cvt_pk_bf16_f32 v96, v96, v96
    ds_write_b16 v42, v96 offset:0
    v_add_f32 v97, v97, v100
    v_add_f32 v97, v97, v103
    v_add_f32 v97, v97, v106
    v_add_f32 v97, v97, v109
    v_add_f32 v97, v97, v112
    v_add_f32 v97, v97, v115
    v_add_f32 v97, v97, v118
    v_cvt_pk_bf16_f32 v97, v97, v97
    ds_write_b16 v42, v97 offset:128
    v_add_f32 v98, v98, v101
    v_add_f32 v98, v98, v104
    v_add_f32 v98, v98, v107
    v_add_f32 v98, v98, v110
    v_add_f32 v98, v98, v113
    v_add_f32 v98, v98, v116
    v_add_f32 v98, v98, v119
    v_cvt_pk_bf16_f32 v98, v98, v98
    ds_write_b16 v42, v98 offset:256
    s_waitcnt lgkmcnt(0)
    ds_read_b128 v[64:67], v43 offset:0
    ds_read_b128 v[68:71], v43 offset:64
    ds_read_b128 v[72:75], v43 offset:128
    ds_read_b128 v[76:79], v43 offset:192
    ds_read_b128 v[80:83], v43 offset:256
    ds_read_b128 v[84:87], v43 offset:320
    s_waitcnt vmcnt(12)
    ds_read_b128 v[96:99], v24 offset:0
    ds_read_b128 v[100:103], v25 offset:0
    ds_read_b128 v[104:107], v26 offset:0
    ds_read_b128 v[108:111], v27 offset:0
    ds_read_b128 v[112:115], v28 offset:0
    ds_read_b128 v[116:119], v29 offset:0
    s_waitcnt lgkmcnt(0)
    s_add_u32 s26, s34, 0
    s_mov_b32 m0, s26
    s_add_u32 s25, s24, 18432
    buffer_load_dwordx4 v16, s[8:11], s25 offen offset:0 nt lds
    buffer_load_dwordx4 v17, s[8:11], s25 offen offset:1024 nt lds
    buffer_load_dwordx4 v18, s[8:11], s25 offen offset:2048 nt lds
    buffer_load_dwordx4 v19, s[8:11], s25 offen offset:3072 nt lds
    s_add_u32 s26, s34, 4096
    s_mov_b32 m0, s26
    s_add_u32 s25, s24, 22528
    buffer_load_dwordx4 v20, s[8:11], s25 offen offset:0 nt lds
    buffer_load_dwordx4 v21, s[8:11], s25 offen offset:1024 nt lds
    v_mfma_f32_16x16x32_bf16 v[44:47], v[64:67], v[96:99], 0
    v_mfma_f32_16x16x32_bf16 v[44:47], v[68:71], v[100:103], v[44:47]
    v_mfma_f32_16x16x32_bf16 v[44:47], v[72:75], v[104:107], v[44:47]
    v_mfma_f32_16x16x32_bf16 v[44:47], v[76:79], v[108:111], v[44:47]
    v_mfma_f32_16x16x32_bf16 v[44:47], v[80:83], v[112:115], v[44:47]
    v_mfma_f32_16x16x32_bf16 v[44:47], v[84:87], v[116:119], v[44:47]
    s_nop 3
    s_waitcnt vmcnt(12)
    ds_read_b128 v[96:99], v24 offset:6144
    ds_read_b128 v[100:103], v25 offset:6144
    ds_read_b128 v[104:107], v26 offset:6144
    ds_read_b128 v[108:111], v27 offset:6144
    ds_read_b128 v[112:115], v28 offset:6144
    ds_read_b128 v[116:119], v29 offset:6144
    s_waitcnt lgkmcnt(0)
    s_add_u32 s26, s34, 6144
    s_mov_b32 m0, s26
    s_add_u32 s25, s24, 0
    buffer_load_dwordx4 v16, s[12:15], s25 offen offset:0 nt lds
    buffer_load_dwordx4 v17, s[12:15], s25 offen offset:1024 nt lds
    buffer_load_dwordx4 v18, s[12:15], s25 offen offset:2048 nt lds
    buffer_load_dwordx4 v19, s[12:15], s25 offen offset:3072 nt lds
    s_add_u32 s26, s34, 10240
    s_mov_b32 m0, s26
    s_add_u32 s25, s24, 4096
    buffer_load_dwordx4 v20, s[12:15], s25 offen offset:0 nt lds
    buffer_load_dwordx4 v21, s[12:15], s25 offen offset:1024 nt lds
    v_mfma_f32_16x16x32_bf16 v[48:51], v[64:67], v[96:99], 0
    v_mfma_f32_16x16x32_bf16 v[48:51], v[68:71], v[100:103], v[48:51]
    v_mfma_f32_16x16x32_bf16 v[48:51], v[72:75], v[104:107], v[48:51]
    v_mfma_f32_16x16x32_bf16 v[48:51], v[76:79], v[108:111], v[48:51]
    v_mfma_f32_16x16x32_bf16 v[48:51], v[80:83], v[112:115], v[48:51]
    v_mfma_f32_16x16x32_bf16 v[48:51], v[84:87], v[116:119], v[48:51]
    s_nop 3
    s_waitcnt vmcnt(12)
    ds_read_b128 v[96:99], v24 offset:12288
    ds_read_b128 v[100:103], v25 offset:12288
    ds_read_b128 v[104:107], v26 offset:12288
    ds_read_b128 v[108:111], v27 offset:12288
    ds_read_b128 v[112:115], v28 offset:12288
    ds_read_b128 v[116:119], v29 offset:12288
    s_waitcnt lgkmcnt(0)
    s_add_u32 s26, s34, 12288
    s_mov_b32 m0, s26
    s_add_u32 s25, s24, 6144
    buffer_load_dwordx4 v16, s[12:15], s25 offen offset:0 nt lds
    buffer_load_dwordx4 v17, s[12:15], s25 offen offset:1024 nt lds
    buffer_load_dwordx4 v18, s[12:15], s25 offen offset:2048 nt lds
    buffer_load_dwordx4 v19, s[12:15], s25 offen offset:3072 nt lds
    s_add_u32 s26, s34, 16384
    s_mov_b32 m0, s26
    s_add_u32 s25, s24, 10240
    buffer_load_dwordx4 v20, s[12:15], s25 offen offset:0 nt lds
    buffer_load_dwordx4 v21, s[12:15], s25 offen offset:1024 nt lds
    v_mfma_f32_16x16x32_bf16 v[52:55], v[64:67], v[96:99], 0
    v_mfma_f32_16x16x32_bf16 v[52:55], v[68:71], v[100:103], v[52:55]
    v_mfma_f32_16x16x32_bf16 v[52:55], v[72:75], v[104:107], v[52:55]
    v_mfma_f32_16x16x32_bf16 v[52:55], v[76:79], v[108:111], v[52:55]
    v_mfma_f32_16x16x32_bf16 v[52:55], v[80:83], v[112:115], v[52:55]
    v_mfma_f32_16x16x32_bf16 v[52:55], v[84:87], v[116:119], v[52:55]
    s_nop 3
    s_waitcnt vmcnt(12)
    ds_read_b128 v[96:99], v24 offset:0
    ds_read_b128 v[100:103], v25 offset:0
    ds_read_b128 v[104:107], v26 offset:0
    ds_read_b128 v[108:111], v27 offset:0
    ds_read_b128 v[112:115], v28 offset:0
    ds_read_b128 v[116:119], v29 offset:0
    s_waitcnt lgkmcnt(0)
    s_add_u32 s26, s34, 0
    s_mov_b32 m0, s26
    s_add_u32 s25, s24, 12288
    buffer_load_dwordx4 v16, s[12:15], s25 offen offset:0 nt lds
    buffer_load_dwordx4 v17, s[12:15], s25 offen offset:1024 nt lds
    buffer_load_dwordx4 v18, s[12:15], s25 offen offset:2048 nt lds
    buffer_load_dwordx4 v19, s[12:15], s25 offen offset:3072 nt lds
    s_add_u32 s26, s34, 4096
    s_mov_b32 m0, s26
    s_add_u32 s25, s24, 16384
    buffer_load_dwordx4 v20, s[12:15], s25 offen offset:0 nt lds
    buffer_load_dwordx4 v21, s[12:15], s25 offen offset:1024 nt lds
    v_mfma_f32_16x16x32_bf16 v[56:59], v[64:67], v[96:99], 0
    v_mfma_f32_16x16x32_bf16 v[56:59], v[68:71], v[100:103], v[56:59]
    v_mfma_f32_16x16x32_bf16 v[56:59], v[72:75], v[104:107], v[56:59]
    v_mfma_f32_16x16x32_bf16 v[56:59], v[76:79], v[108:111], v[56:59]
    v_mfma_f32_16x16x32_bf16 v[56:59], v[80:83], v[112:115], v[56:59]
    v_mfma_f32_16x16x32_bf16 v[56:59], v[84:87], v[116:119], v[56:59]
    s_nop 3
    s_nop 7
    v_cvt_pk_bf16_f32 v44, v44, v44
    v_lshlrev_b32 v44, 16, v44
    v_mul_f32 v44, s28, v44
    v_cvt_pk_bf16_f32 v44, v44, v44
    v_lshlrev_b32 v44, 16, v44
    v_cvt_pk_bf16_f32 v48, v48, v48
    v_lshlrev_b32 v48, 16, v48
    v_mul_f32 v48, s28, v48
    v_cvt_pk_bf16_f32 v48, v48, v48
    v_lshlrev_b32 v48, 16, v48
    v_cvt_pk_bf16_f32 v52, v52, v52
    v_lshlrev_b32 v52, 16, v52
    v_mul_f32 v52, s28, v52
    v_cvt_pk_bf16_f32 v52, v52, v52
    v_lshlrev_b32 v52, 16, v52
    v_cvt_pk_bf16_f32 v56, v56, v56
    v_lshlrev_b32 v56, 16, v56
    v_mul_f32 v56, s28, v56
    v_cvt_pk_bf16_f32 v56, v56, v56
    v_lshlrev_b32 v56, 16, v56
    v_max_f32 v11, v44, v48
    v_max3_f32 v11, v11, v52, v56
    s_nop 1
    v_max_f32_dpp v11, v11, v11 row_ror:1 row_mask:0xf bank_mask:0xf
    s_nop 1
    v_max_f32_dpp v11, v11, v11 row_ror:2 row_mask:0xf bank_mask:0xf
    s_nop 1
    v_max_f32_dpp v11, v11, v11 row_ror:4 row_mask:0xf bank_mask:0xf
    s_nop 1
    v_max_f32_dpp v11, v11, v11 row_ror:8 row_mask:0xf bank_mask:0xf
    v_sub_f32 v44, v44, v11
    v_mul_f32 v44, s29, v44
    v_exp_f32 v44, v44
    v_sub_f32 v48, v48, v11
    v_mul_f32 v48, s29, v48
    v_exp_f32 v48, v48
    v_sub_f32 v52, v52, v11
    v_mul_f32 v52, s29, v52
    v_exp_f32 v52, v52
    v_sub_f32 v56, v56, v11
    v_mul_f32 v56, s29, v56
    v_exp_f32 v56, v56
    s_nop 0
    v_add_f32 v12, v44, v48
    v_add_f32 v12, v12, v52
    v_add_f32 v12, v12, v56
    v_mov_b32 v30, v44
    v_cmp_eq_u32 vcc, 1, v7
    s_nop 1
    v_cndmask_b32 v30, v30, v48, vcc
    v_cmp_eq_u32 vcc, 2, v7
    s_nop 1
    v_cndmask_b32 v30, v30, v52, vcc
    v_cmp_eq_u32 vcc, 3, v7
    s_nop 1
    v_cndmask_b32 v30, v30, v56, vcc
    v_cvt_pk_bf16_f32 v30, v30, v30
    ds_write_b16 v42, v30 offset:384
    s_nop 1
    v_add_f32_dpp v12, v12, v12 row_ror:1 row_mask:0xf bank_mask:0xf
    s_nop 1
    v_add_f32_dpp v12, v12, v12 row_ror:2 row_mask:0xf bank_mask:0xf
    s_nop 1
    v_add_f32_dpp v12, v12, v12 row_ror:4 row_mask:0xf bank_mask:0xf
    s_nop 1
    v_add_f32_dpp v12, v12, v12 row_ror:8 row_mask:0xf bank_mask:0xf
    s_waitcnt lgkmcnt(0)
    ds_read_b128 v[60:63], v43 offset:384
    ds_read_b128 v[64:67], v43 offset:448
    s_waitcnt vmcnt(6)
    ds_read_b64_tr_b16 v[96:97], v32 offset:6144
    ds_read_b64_tr_b16 v[98:99], v36 offset:6144
    ds_read_b64_tr_b16 v[100:101], v33 offset:6144
    ds_read_b64_tr_b16 v[102:103], v37 offset:6144
    ds_read_b64_tr_b16 v[104:105], v34 offset:6144
    ds_read_b64_tr_b16 v[106:107], v38 offset:6144
    ds_read_b64_tr_b16 v[108:109], v35 offset:6144
    ds_read_b64_tr_b16 v[110:111], v39 offset:6144
    s_waitcnt lgkmcnt(0)
    v_mfma_f32_16x16x32_bf16 v[120:123], v[60:63], v[96:99], 0
    v_mfma_f32_16x16x32_bf16 v[124:127], v[60:63], v[100:103], 0
    v_mfma_f32_16x16x32_bf16 v[128:131], v[60:63], v[104:107], 0
    v_mfma_f32_16x16x32_bf16 v[132:135], v[60:63], v[108:111], 0
    s_nop 3
    ds_read_b64_tr_b16 v[96:97], v32 offset:6272
    ds_read_b64_tr_b16 v[98:99], v36 offset:6272
    ds_read_b64_tr_b16 v[100:101], v33 offset:6272
    ds_read_b64_tr_b16 v[102:103], v37 offset:6272
    ds_read_b64_tr_b16 v[104:105], v34 offset:6272
    ds_read_b64_tr_b16 v[106:107], v38 offset:6272
    ds_read_b64_tr_b16 v[108:109], v35 offset:6272
    ds_read_b64_tr_b16 v[110:111], v39 offset:6272
    s_waitcnt lgkmcnt(0)
    v_mfma_f32_16x16x32_bf16 v[136:139], v[60:63], v[96:99], 0
    v_mfma_f32_16x16x32_bf16 v[140:143], v[60:63], v[100:103], 0
    v_mfma_f32_16x16x32_bf16 v[144:147], v[60:63], v[104:107], 0
    v_mfma_f32_16x16x32_bf16 v[148:151], v[60:63], v[108:111], 0
    s_nop 3
    ds_read_b64_tr_b16 v[96:97], v32 offset:6400
    ds_read_b64_tr_b16 v[98:99], v36 offset:6400
    ds_read_b64_tr_b16 v[100:101], v33 offset:6400
    ds_read_b64_tr_b16 v[102:103], v37 offset:6400
    ds_read_b64_tr_b16 v[104:105], v34 offset:6400
    ds_read_b64_tr_b16 v[106:107], v38 offset:6400
    ds_read_b64_tr_b16 v[108:109], v35 offset:6400
    ds_read_b64_tr_b16 v[110:111], v39 offset:6400
    s_waitcnt lgkmcnt(0)
    v_mfma_f32_16x16x32_bf16 v[152:155], v[60:63], v[96:99], 0
    v_mfma_f32_16x16x32_bf16 v[156:159], v[60:63], v[100:103], 0
    v_mfma_f32_16x16x32_bf16 v[160:163], v[60:63], v[104:107], 0
    v_mfma_f32_16x16x32_bf16 v[164:167], v[60:63], v[108:111], 0
    s_nop 3
    s_add_u32 s26, s34, 6144
    s_mov_b32 m0, s26
    s_add_u32 s25, s24, 18432
    buffer_load_dwordx4 v16, s[12:15], s25 offen offset:0 nt lds
    buffer_load_dwordx4 v17, s[12:15], s25 offen offset:1024 nt lds
    buffer_load_dwordx4 v18, s[12:15], s25 offen offset:2048 nt lds
    buffer_load_dwordx4 v19, s[12:15], s25 offen offset:3072 nt lds
    s_add_u32 s26, s34, 10240
    s_mov_b32 m0, s26
    s_add_u32 s25, s24, 22528
    buffer_load_dwordx4 v20, s[12:15], s25 offen offset:0 nt lds
    buffer_load_dwordx4 v21, s[12:15], s25 offen offset:1024 nt lds
    s_waitcnt vmcnt(0)
    ds_read_b64_tr_b16 v[96:97], v32 offset:0
    ds_read_b64_tr_b16 v[98:99], v36 offset:0
    ds_read_b64_tr_b16 v[100:101], v33 offset:0
    ds_read_b64_tr_b16 v[102:103], v37 offset:0
    ds_read_b64_tr_b16 v[104:105], v34 offset:0
    ds_read_b64_tr_b16 v[106:107], v38 offset:0
    ds_read_b64_tr_b16 v[108:109], v35 offset:0
    ds_read_b64_tr_b16 v[110:111], v39 offset:0
    s_waitcnt lgkmcnt(0)
    v_mfma_f32_16x16x32_bf16 v[120:123], v[64:67], v[96:99], v[120:123]
    v_mfma_f32_16x16x32_bf16 v[124:127], v[64:67], v[100:103], v[124:127]
    v_mfma_f32_16x16x32_bf16 v[128:131], v[64:67], v[104:107], v[128:131]
    v_mfma_f32_16x16x32_bf16 v[132:135], v[64:67], v[108:111], v[132:135]
    s_nop 3
    ds_read_b64_tr_b16 v[96:97], v32 offset:128
    ds_read_b64_tr_b16 v[98:99], v36 offset:128
    ds_read_b64_tr_b16 v[100:101], v33 offset:128
    ds_read_b64_tr_b16 v[102:103], v37 offset:128
    ds_read_b64_tr_b16 v[104:105], v34 offset:128
    ds_read_b64_tr_b16 v[106:107], v38 offset:128
    ds_read_b64_tr_b16 v[108:109], v35 offset:128
    ds_read_b64_tr_b16 v[110:111], v39 offset:128
    s_waitcnt lgkmcnt(0)
    v_mfma_f32_16x16x32_bf16 v[136:139], v[64:67], v[96:99], v[136:139]
    v_mfma_f32_16x16x32_bf16 v[140:143], v[64:67], v[100:103], v[140:143]
    v_mfma_f32_16x16x32_bf16 v[144:147], v[64:67], v[104:107], v[144:147]
    v_mfma_f32_16x16x32_bf16 v[148:151], v[64:67], v[108:111], v[148:151]
    s_nop 3
    ds_read_b64_tr_b16 v[96:97], v32 offset:256
    ds_read_b64_tr_b16 v[98:99], v36 offset:256
    ds_read_b64_tr_b16 v[100:101], v33 offset:256
    ds_read_b64_tr_b16 v[102:103], v37 offset:256
    ds_read_b64_tr_b16 v[104:105], v34 offset:256
    ds_read_b64_tr_b16 v[106:107], v38 offset:256
    ds_read_b64_tr_b16 v[108:109], v35 offset:256
    ds_read_b64_tr_b16 v[110:111], v39 offset:256
    s_waitcnt lgkmcnt(0)
    v_mfma_f32_16x16x32_bf16 v[152:155], v[64:67], v[96:99], v[152:155]
    v_mfma_f32_16x16x32_bf16 v[156:159], v[64:67], v[100:103], v[156:159]
    v_mfma_f32_16x16x32_bf16 v[160:163], v[64:67], v[104:107], v[160:163]
    v_mfma_f32_16x16x32_bf16 v[164:167], v[64:67], v[108:111], v[164:167]
    s_nop 3
    s_nop 7
    v_mul_u32_u24 v13, 18432, v2
    v_lshl_add_u32 v14, v1, 2, v13
    v_mov_b32 v18, v11
    v_mov_b32 v19, v12
    v_cmp_gt_u32 vcc, 16, v1
    s_and_saveexec_b64 s[30:31], vcc
    ds_write_b32 v14, v120 offset:0
    ds_write_b32 v14, v124 offset:64
    ds_write_b32 v14, v128 offset:128
    ds_write_b32 v14, v132 offset:192
    ds_write_b32 v14, v136 offset:256
    ds_write_b32 v14, v140 offset:320
    ds_write_b32 v14, v144 offset:384
    ds_write_b32 v14, v148 offset:448
    ds_write_b32 v14, v152 offset:512
    ds_write_b32 v14, v156 offset:576
    ds_write_b32 v14, v160 offset:640
    ds_write_b32 v14, v164 offset:704
    ds_write_b64 v13, v[18:19] offset:768
    s_mov_b64 exec, s[30:31]
    s_waitcnt lgkmcnt(0)
    s_barrier
    v_and_b32 v16, 255, v0
    v_mov_b32 v15, s35
    v_mov_b32 v18, 0
    v_lshl_add_u32 v17, v16, 2, v18
    ds_read_b64 v[20:21], v18 offset:768
    ds_read_b32 v30, v17 offset:0
    ds_read_b64 v[22:23], v18 offset:19200
    ds_read_b32 v31, v17 offset:18432
    ds_read_b64 v[24:25], v18 offset:37632
    ds_read_b32 v32, v17 offset:36864
    ds_read_b64 v[26:27], v18 offset:56064
    ds_read_b32 v33, v17 offset:55296
    s_waitcnt lgkmcnt(0)
    v_max_f32 v34, v20, v22
    v_max3_f32 v34, v34, v24, v26
    v_sub_f32 v20, v20, v34
    v_mul_f32 v20, s29, v20
    v_exp_f32 v20, v20
    v_sub_f32 v22, v22, v34
    v_mul_f32 v22, s29, v22
    v_exp_f32 v22, v22
    v_sub_f32 v24, v24, v34
    v_mul_f32 v24, s29, v24
    v_exp_f32 v24, v24
    v_sub_f32 v26, v26, v34
    v_mul_f32 v26, s29, v26
    v_exp_f32 v26, v26
    s_nop 0
    v_mul_f32 v35, v20, v21
    v_mul_f32 v36, v20, v30
    v_fmac_f32 v35, v22, v23
    v_fmac_f32 v36, v22, v31
    v_fmac_f32 v35, v24, v25
    v_fmac_f32 v36, v24, v32
    v_fmac_f32 v35, v26, v27
    v_fmac_f32 v36, v26, v33
    v_cmp_eq_u32 vcc, 192, v16
    s_nop 1
    v_cndmask_b32 v36, v36, v34, vcc
    v_cmp_eq_u32 vcc, 193, v16
    s_nop 1
    v_cndmask_b32 v36, v36, v35, vcc
    v_cmp_gt_u32 vcc, 194, v16
    s_and_saveexec_b64 s[30:31], vcc
    s_cbranch_execz ka_done
    s_lshl_b32 s22, s20, 3
    s_add_u32 s22, s22, s21
    s_lshl_b32 s22, s22, 10
    s_add_u32 s22, s22, 65536
    v_lshlrev_b32 v17, 18, v15
    v_lshl_add_u32 v17, v16, 2, v17
    buffer_store_dword v36, v17, s[16:19], s22 offen
ka_done:
    s_endpgm
.globl kt_kernel
.p2align 8
.type kt_kernel,@function
kt_kernel:
    s_cmp_ge_u32 s2, 276
    s_cbranch_scc1 kt_done
    s_cmp_ge_u32 s2, 256
    s_cbranch_scc1 kt_role_d
    s_cmp_ge_u32 s2, 160
    s_cbranch_scc1 kt_role_c
    s_load_dwordx2 s[12:13], s[0:1], 32
    s_load_dwordx2 s[16:17], s[0:1], 88
    s_load_dwordx2 s[60:61], s[0:1], 80
    s_waitcnt lgkmcnt(0)
    s_and_b32 s13, s13, 0xffff
    s_mov_b32 s14, 7864320
    s_mov_b32 s15, 0x00020000
    s_and_b32 s17, s17, 0xffff
    s_mov_b32 s18, 805306368
    s_mov_b32 s19, 0x00020000
    s_and_b32 s61, s61, 0xffff
    s_mov_b32 s62, 256
    s_mov_b32 s63, 0x00020000
    v_and_b32 v1, 63, v0
    v_lshrrev_b32 v2, 6, v0
    v_lshlrev_b32 v3, 2, v1
    s_and_b32 s20, s2, 7
    s_lshr_b32 s21, s2, 3
    v_lshrrev_b32 v6, 5, v1
    v_and_b32 v7, 31, v1
    v_lshlrev_b32 v6, 18, v6
    v_lshl_add_u32 v6, v7, 10, v6
    s_lshl_b32 s22, s20, 15
    s_add_u32 s22, s22, 65536
    buffer_load_dwordx2 v[8:9], v6, s[16:19], s22 offen offset:768
    v_add_u32 v10, 0, v0
    v_mul_u32_u24 v11, 21846, v10
    v_lshrrev_b32 v11, 22, v11
    v_mul_u32_u24 v12, 192, v11
    v_sub_u32 v12, v10, v12
    v_lshlrev_b32 v13, 13, v11
    v_lshl_add_u32 v13, v12, 2, v13
    v_lshlrev_b32 v16, 5, v11
    v_add_u32 v10, 256, v0
    v_mul_u32_u24 v11, 21846, v10
    v_lshrrev_b32 v11, 22, v11
    v_mul_u32_u24 v12, 192, v11
    v_sub_u32 v12, v10, v12
    v_lshlrev_b32 v14, 13, v11
    v_lshl_add_u32 v14, v12, 2, v14
    v_lshlrev_b32 v17, 5, v11
    v_add_u32 v10, 512, v0
    v_mul_u32_u24 v11, 21846, v10
    v_lshrrev_b32 v11, 22, v11
    v_mul_u32_u24 v12, 192, v11
    v_sub_u32 v12, v10, v12
    v_lshlrev_b32 v15, 13, v11
    v_lshl_add_u32 v15, v12, 2, v15
    v_lshlrev_b32 v18, 5, v11
    s_add_u32 s23, s22, 4096
    s_add_u32 s24, s22, 262144
    s_add_u32 s25, s24, 4096
    buffer_load_dword v64, v13, s[16:19], s22 offen offset:0
    buffer_load_dword v65, v13, s[16:19], s22 offen offset:1024
    buffer_load_dword v66, v13, s[16:19], s22 offen offset:2048
    buffer_load_dword v67, v13, s[16:19], s22 offen offset:3072
    buffer_load_dword v68, v13, s[16:19], s23 offen offset:0
    buffer_load_dword v69, v13, s[16:19], s23 offen offset:1024
    buffer_load_dword v70, v13, s[16:19], s23 offen offset:2048
    buffer_load_dword v71, v13, s[16:19], s23 offen offset:3072
    buffer_load_dword v72, v13, s[16:19], s24 offen offset:0
    buffer_load_dword v73, v13, s[16:19], s24 offen offset:1024
    buffer_load_dword v74, v13, s[16:19], s24 offen offset:2048
    buffer_load_dword v75, v13, s[16:19], s24 offen offset:3072
    buffer_load_dword v76, v13, s[16:19], s25 offen offset:0
    buffer_load_dword v77, v13, s[16:19], s25 offen offset:1024
    buffer_load_dword v78, v13, s[16:19], s25 offen offset:2048
    buffer_load_dword v79, v13, s[16:19], s25 offen offset:3072
    buffer_load_dword v80, v14, s[16:19], s22 offen offset:0
    buffer_load_dword v81, v14, s[16:19], s22 offen offset:1024
    buffer_load_dword v82, v14, s[16:19], s22 offen offset:2048
    buffer_load_dword v83, v14, s[16:19], s22 offen offset:3072
    buffer_load_dword v84, v14, s[16:19], s23 offen offset:0
    buffer_load_dword v85, v14, s[16:19], s23 offen offset:1024
    buffer_load_dword v86, v14, s[16:19], s23 offen offset:2048
    buffer_load_dword v87, v14, s[16:19], s23 offen offset:3072
    buffer_load_dword v88, v14, s[16:19], s24 offen offset:0
    buffer_load_dword v89, v14, s[16:19], s24 offen offset:1024
    buffer_load_dword v90, v14, s[16:19], s24 offen offset:2048
    buffer_load_dword v91, v14, s[16:19], s24 offen offset:3072
    buffer_load_dword v92, v14, s[16:19], s25 offen offset:0
    buffer_load_dword v93, v14, s[16:19], s25 offen offset:1024
    buffer_load_dword v94, v14, s[16:19], s25 offen offset:2048
    buffer_load_dword v95, v14, s[16:19], s25 offen offset:3072
    buffer_load_dword v96, v15, s[16:19], s22 offen offset:0
    buffer_load_dword v97, v15, s[16:19], s22 offen offset:1024
    buffer_load_dword v98, v15, s[16:19], s22 offen offset:2048
    buffer_load_dword v99, v15, s[16:19], s22 offen offset:3072
    buffer_load_dword v100, v15, s[16:19], s23 offen offset:0
    buffer_load_dword v101, v15, s[16:19], s23 offen offset:1024
    buffer_load_dword v102, v15, s[16:19], s23 offen offset:2048
    buffer_load_dword v103, v15, s[16:19], s23 offen offset:3072
    buffer_load_dword v104, v15, s[16:19], s24 offen offset:0
    buffer_load_dword v105, v15, s[16:19], s24 offen offset:1024
    buffer_load_dword v106, v15, s[16:19], s24 offen offset:2048
    buffer_load_dword v107, v15, s[16:19], s24 offen offset:3072
    buffer_load_dword v108, v15, s[16:19], s25 offen offset:0
    buffer_load_dword v109, v15, s[16:19], s25 offen offset:1024
    buffer_load_dword v110, v15, s[16:19], s25 offen offset:2048
    buffer_load_dword v111, v15, s[16:19], s25 offen offset:3072
    v_and_b32 v28, 3, v0
    v_lshrrev_b32 v29, 2, v0
    v_mul_u32_u24 v30, 1280, v29
    v_lshl_add_u32 v30, v28, 4, v30
    s_mul_i32 s26, s20, 983040
    s_lshl_b32 s27, s21, 6
    s_add_u32 s26, s26, s27
    buffer_load_dwordx4 v[112:115], v30, s[12:15], s26 offen nt
    s_add_u32 s26, s26, 81920
    buffer_load_dwordx4 v[116:119], v30, s[12:15], s26 offen nt
    s_add_u32 s26, s26, 81920
    buffer_load_dwordx4 v[120:123], v30, s[12:15], s26 offen nt
    s_add_u32 s26, s26, 81920
    buffer_load_dwordx4 v[124:127], v30, s[12:15], s26 offen nt
    s_add_u32 s26, s26, 81920
    buffer_load_dwordx4 v[128:131], v30, s[12:15], s26 offen nt
    s_add_u32 s26, s26, 81920
    buffer_load_dwordx4 v[132:135], v30, s[12:15], s26 offen nt
    s_add_u32 s26, s26, 81920
    buffer_load_dwordx4 v[136:139], v30, s[12:15], s26 offen nt
    s_add_u32 s26, s26, 81920
    buffer_load_dwordx4 v[140:143], v30, s[12:15], s26 offen nt
    s_add_u32 s26, s26, 81920
    buffer_load_dwordx4 v[144:147], v30, s[12:15], s26 offen nt
    s_add_u32 s26, s26, 81920
    buffer_load_dwordx4 v[148:151], v30, s[12:15], s26 offen nt
    s_add_u32 s26, s26, 81920
    buffer_load_dwordx4 v[152:155], v30, s[12:15], s26 offen nt
    s_add_u32 s26, s26, 81920
    buffer_load_dwordx4 v[156:159], v30, s[12:15], s26 offen nt
    s_mov_b32 s29, 0x3fb8aa3b
    s_waitcnt vmcnt(60)
    v_mov_b32 v10, v8
    s_nop 1
    ds_swizzle_b32 v11, v10 offset:1055
    s_waitcnt lgkmcnt(0)
    v_max_f32 v10, v10, v11
    s_nop 1
    ds_swizzle_b32 v11, v10 offset:2079
    s_waitcnt lgkmcnt(0)
    v_max_f32 v10, v10, v11
    s_nop 1
    ds_swizzle_b32 v11, v10 offset:4127
    s_waitcnt lgkmcnt(0)
    v_max_f32 v10, v10, v11
    v_sub_f32 v8, v8, v10
    v_mul_f32 v8, s29, v8
    v_exp_f32 v8, v8
    s_nop 0
    v_mul_f32 v9, v8, v9
    ds_swizzle_b32 v11, v9 offset:1055
    s_waitcnt lgkmcnt(0)
    v_add_f32 v9, v9, v11
    ds_swizzle_b32 v11, v9 offset:2079
    s_waitcnt lgkmcnt(0)
    v_add_f32 v9, v9, v11
    ds_swizzle_b32 v11, v9 offset:4127
    s_waitcnt lgkmcnt(0)
    v_add_f32 v9, v9, v11
    v_rcp_f32 v9, v9
    s_nop 0
    v_mul_f32 v8, v8, v9
    ds_write_b32 v3, v8
    s_waitcnt lgkmcnt(0)
    s_barrier
    s_waitcnt vmcnt(12)
    ds_read_b128 v[20:23], v16 offset:0
    ds_read_b128 v[24:27], v16 offset:16
    s_waitcnt lgkmcnt(0)
    v_mul_f32 v8, v20, v64
    v_fmac_f32 v8, v21, v65
    v_fmac_f32 v8, v22, v66
    v_fmac_f32 v8, v23, v67
    v_fmac_f32 v8, v24, v68
    v_fmac_f32 v8, v25, v69
    v_fmac_f32 v8, v26, v70
    v_fmac_f32 v8, v27, v71
    v_cvt_pk_bf16_f32 v8, v8, v8
    v_lshlrev_b32 v8, 16, v8
    ds_read_b128 v[20:23], v16 offset:128
    ds_read_b128 v[24:27], v16 offset:144
    s_waitcnt lgkmcnt(0)
    v_mul_f32 v9, v20, v72
    v_fmac_f32 v9, v21, v73
    v_fmac_f32 v9, v22, v74
    v_fmac_f32 v9, v23, v75
    v_fmac_f32 v9, v24, v76
    v_fmac_f32 v9, v25, v77
    v_fmac_f32 v9, v26, v78
    v_fmac_f32 v9, v27, v79
    v_cvt_pk_bf16_f32 v9, v9, v9
    v_lshlrev_b32 v9, 16, v9
    v_lshlrev_b32 v10, 3, v0
    ds_write_b64 v10, v[8:9] offset:256
    ds_read_b128 v[20:23], v17 offset:0
    ds_read_b128 v[24:27], v17 offset:16
    s_waitcnt lgkmcnt(0)
    v_mul_f32 v8, v20, v80
    v_fmac_f32 v8, v21, v81
    v_fmac_f32 v8, v22, v82
    v_fmac_f32 v8, v23, v83
    v_fmac_f32 v8, v24, v84
    v_fmac_f32 v8, v25, v85
    v_fmac_f32 v8, v26, v86
    v_fmac_f32 v8, v27, v87
    v_cvt_pk_bf16_f32 v8, v8, v8
    v_lshlrev_b32 v8, 16, v8
    ds_read_b128 v[20:23], v17 offset:128
    ds_read_b128 v[24:27], v17 offset:144
    s_waitcnt lgkmcnt(0)
    v_mul_f32 v9, v20, v88
    v_fmac_f32 v9, v21, v89
    v_fmac_f32 v9, v22, v90
    v_fmac_f32 v9, v23, v91
    v_fmac_f32 v9, v24, v92
    v_fmac_f32 v9, v25, v93
    v_fmac_f32 v9, v26, v94
    v_fmac_f32 v9, v27, v95
    v_cvt_pk_bf16_f32 v9, v9, v9
    v_lshlrev_b32 v9, 16, v9
    v_lshlrev_b32 v10, 3, v0
    ds_write_b64 v10, v[8:9] offset:2304
    ds_read_b128 v[20:23], v18 offset:0
    ds_read_b128 v[24:27], v18 offset:16
    s_waitcnt lgkmcnt(0)
    v_mul_f32 v8, v20, v96
    v_fmac_f32 v8, v21, v97
    v_fmac_f32 v8, v22, v98
    v_fmac_f32 v8, v23, v99
    v_fmac_f32 v8, v24, v100
    v_fmac_f32 v8, v25, v101
    v_fmac_f32 v8, v26, v102
    v_fmac_f32 v8, v27, v103
    v_cvt_pk_bf16_f32 v8, v8, v8
    v_lshlrev_b32 v8, 16, v8
    ds_read_b128 v[20:23], v18 offset:128
    ds_read_b128 v[24:27], v18 offset:144
    s_waitcnt lgkmcnt(0)
    v_mul_f32 v9, v20, v104
    v_fmac_f32 v9, v21, v105
    v_fmac_f32 v9, v22, v106
    v_fmac_f32 v9, v23, v107
    v_fmac_f32 v9, v24, v108
    v_fmac_f32 v9, v25, v109
    v_fmac_f32 v9, v26, v110
    v_fmac_f32 v9, v27, v111
    v_cvt_pk_bf16_f32 v9, v9, v9
    v_lshlrev_b32 v9, 16, v9
    v_lshlrev_b32 v10, 3, v0
    ds_write_b64 v10, v[8:9] offset:4352
    s_waitcnt lgkmcnt(0)
    s_barrier
    v_lshlrev_b32 v24, 3, v29
    ds_read_b64 v[64:65], v24 offset:256
    ds_read_b64 v[66:67], v24 offset:768
    ds_read_b64 v[68:69], v24 offset:1280
    ds_read_b64 v[70:71], v24 offset:1792
    ds_read_b64 v[72:73], v24 offset:2304
    ds_read_b64 v[74:75], v24 offset:2816
    ds_read_b64 v[76:77], v24 offset:3328
    ds_read_b64 v[78:79], v24 offset:3840
    ds_read_b64 v[80:81], v24 offset:4352
    ds_read_b64 v[82:83], v24 offset:4864
    ds_read_b64 v[84:85], v24 offset:5376
    ds_read_b64 v[86:87], v24 offset:5888
    v_mov_b32 v96, 0
    v_mov_b32 v97, 0
    v_mov_b32 v98, 0
    v_mov_b32 v99, 0
    v_mov_b32 v100, 0
    v_mov_b32 v101, 0
    v_mov_b32 v102, 0
    v_mov_b32 v103, 0
    v_mov_b32 v104, 0
    v_mov_b32 v105, 0
    v_mov_b32 v106, 0
    v_mov_b32 v107, 0
    v_mov_b32 v108, 0
    v_mov_b32 v109, 0
    v_mov_b32 v110, 0
    v_mov_b32 v111, 0
    s_waitcnt lgkmcnt(0)
    s_waitcnt vmcnt(11)
    v_lshlrev_b32 v4, 16, v112
    v_and_b32 v5, 0xffff0000, v112
    v_fmac_f32 v96, v64, v4
    v_fmac_f32 v97, v64, v5
    v_fmac_f32 v104, v65, v4
    v_fmac_f32 v105, v65, v5
    v_lshlrev_b32 v4, 16, v113
    v_and_b32 v5, 0xffff0000, v113
    v_fmac_f32 v98, v64, v4
    v_fmac_f32 v99, v64, v5
    v_fmac_f32 v106, v65, v4
    v_fmac_f32 v107, v65, v5
    v_lshlrev_b32 v4, 16, v114
    v_and_b32 v5, 0xffff0000, v114
    v_fmac_f32 v100, v64, v4
    v_fmac_f32 v101, v64, v5
    v_fmac_f32 v108, v65, v4
    v_fmac_f32 v109, v65, v5
    v_lshlrev_b32 v4, 16, v115
    v_and_b32 v5, 0xffff0000, v115
    v_fmac_f32 v102, v64, v4
    v_fmac_f32 v103, v64, v5
    v_fmac_f32 v110, v65, v4
    v_fmac_f32 v111, v65, v5
    s_waitcnt vmcnt(10)
    v_lshlrev_b32 v4, 16, v116
    v_and_b32 v5, 0xffff0000, v116
    v_fmac_f32 v96, v66, v4
    v_fmac_f32 v97, v66, v5
    v_fmac_f32 v104, v67, v4
    v_fmac_f32 v105, v67, v5
    v_lshlrev_b32 v4, 16, v117
    v_and_b32 v5, 0xffff0000, v117
    v_fmac_f32 v98, v66, v4
    v_fmac_f32 v99, v66, v5
    v_fmac_f32 v106, v67, v4
    v_fmac_f32 v107, v67, v5
    v_lshlrev_b32 v4, 16, v118
    v_and_b32 v5, 0xffff0000, v118
    v_fmac_f32 v100, v66, v4
    v_fmac_f32 v101, v66, v5
    v_fmac_f32 v108, v67, v4
    v_fmac_f32 v109, v67, v5
    v_lshlrev_b32 v4, 16, v119
    v_and_b32 v5, 0xffff0000, v119
    v_fmac_f32 v102, v66, v4
    v_fmac_f32 v103, v66, v5
    v_fmac_f32 v110, v67, v4
    v_fmac_f32 v111, v67, v5
    s_waitcnt vmcnt(9)
    v_lshlrev_b32 v4, 16, v120
    v_and_b32 v5, 0xffff0000, v120
    v_fmac_f32 v96, v68, v4
    v_fmac_f32 v97, v68, v5
    v_fmac_f32 v104, v69, v4
    v_fmac_f32 v105, v69, v5
    v_lshlrev_b32 v4, 16, v121
    v_and_b32 v5, 0xffff0000, v121
    v_fmac_f32 v98, v68, v4
    v_fmac_f32 v99, v68, v5
    v_fmac_f32 v106, v69, v4
    v_fmac_f32 v107, v69, v5
    v_lshlrev_b32 v4, 16, v122
    v_and_b32 v5, 0xffff0000, v122
    v_fmac_f32 v100, v68, v4
    v_fmac_f32 v101, v68, v5
    v_fmac_f32 v108, v69, v4
    v_fmac_f32 v109, v69, v5
    v_lshlrev_b32 v4, 16, v123
    v_and_b32 v5, 0xffff0000, v123
    v_fmac_f32 v102, v68, v4
    v_fmac_f32 v103, v68, v5
    v_fmac_f32 v110, v69, v4
    v_fmac_f32 v111, v69, v5
    s_waitcnt vmcnt(8)
    v_lshlrev_b32 v4, 16, v124
    v_and_b32 v5, 0xffff0000, v124
    v_fmac_f32 v96, v70, v4
    v_fmac_f32 v97, v70, v5
    v_fmac_f32 v104, v71, v4
    v_fmac_f32 v105, v71, v5
    v_lshlrev_b32 v4, 16, v125
    v_and_b32 v5, 0xffff0000, v125
    v_fmac_f32 v98, v70, v4
    v_fmac_f32 v99, v70, v5
    v_fmac_f32 v106, v71, v4
    v_fmac_f32 v107, v71, v5
    v_lshlrev_b32 v4, 16, v126
    v_and_b32 v5, 0xffff0000, v126
    v_fmac_f32 v100, v70, v4
    v_fmac_f32 v101, v70, v5
    v_fmac_f32 v108, v71, v4
    v_fmac_f32 v109, v71, v5
    v_lshlrev_b32 v4, 16, v127
    v_and_b32 v5, 0xffff0000, v127
    v_fmac_f32 v102, v70, v4
    v_fmac_f32 v103, v70, v5
    v_fmac_f32 v110, v71, v4
    v_fmac_f32 v111, v71, v5
    s_waitcnt vmcnt(7)
    v_lshlrev_b32 v4, 16, v128
    v_and_b32 v5, 0xffff0000, v128
    v_fmac_f32 v96, v72, v4
    v_fmac_f32 v97, v72, v5
    v_fmac_f32 v104, v73, v4
    v_fmac_f32 v105, v73, v5
    v_lshlrev_b32 v4, 16, v129
    v_and_b32 v5, 0xffff0000, v129
    v_fmac_f32 v98, v72, v4
    v_fmac_f32 v99, v72, v5
    v_fmac_f32 v106, v73, v4
    v_fmac_f32 v107, v73, v5
    v_lshlrev_b32 v4, 16, v130
    v_and_b32 v5, 0xffff0000, v130
    v_fmac_f32 v100, v72, v4
    v_fmac_f32 v101, v72, v5
    v_fmac_f32 v108, v73, v4
    v_fmac_f32 v109, v73, v5
    v_lshlrev_b32 v4, 16, v131
    v_and_b32 v5, 0xffff0000, v131
    v_fmac_f32 v102, v72, v4
    v_fmac_f32 v103, v72, v5
    v_fmac_f32 v110, v73, v4
    v_fmac_f32 v111, v73, v5
    s_waitcnt vmcnt(6)
    v_lshlrev_b32 v4, 16, v132
    v_and_b32 v5, 0xffff0000, v132
    v_fmac_f32 v96, v74, v4
    v_fmac_f32 v97, v74, v5
    v_fmac_f32 v104, v75, v4
    v_fmac_f32 v105, v75, v5
    v_lshlrev_b32 v4, 16, v133
    v_and_b32 v5, 0xffff0000, v133
    v_fmac_f32 v98, v74, v4
    v_fmac_f32 v99, v74, v5
    v_fmac_f32 v106, v75, v4
    v_fmac_f32 v107, v75, v5
    v_lshlrev_b32 v4, 16, v134
    v_and_b32 v5, 0xffff0000, v134
    v_fmac_f32 v100, v74, v4
    v_fmac_f32 v101, v74, v5
    v_fmac_f32 v108, v75, v4
    v_fmac_f32 v109, v75, v5
    v_lshlrev_b32 v4, 16, v135
    v_and_b32 v5, 0xffff0000, v135
    v_fmac_f32 v102, v74, v4
    v_fmac_f32 v103, v74, v5
    v_fmac_f32 v110, v75, v4
    v_fmac_f32 v111, v75, v5
    s_waitcnt vmcnt(5)
    v_lshlrev_b32 v4, 16, v136
    v_and_b32 v5, 0xffff0000, v136
    v_fmac_f32 v96, v76, v4
    v_fmac_f32 v97, v76, v5
    v_fmac_f32 v104, v77, v4
    v_fmac_f32 v105, v77, v5
    v_lshlrev_b32 v4, 16, v137
    v_and_b32 v5, 0xffff0000, v137
    v_fmac_f32 v98, v76, v4
    v_fmac_f32 v99, v76, v5
    v_fmac_f32 v106, v77, v4
    v_fmac_f32 v107, v77, v5
    v_lshlrev_b32 v4, 16, v138
    v_and_b32 v5, 0xffff0000, v138
    v_fmac_f32 v100, v76, v4
    v_fmac_f32 v101, v76, v5
    v_fmac_f32 v108, v77, v4
    v_fmac_f32 v109, v77, v5
    v_lshlrev_b32 v4, 16, v139
    v_and_b32 v5, 0xffff0000, v139
    v_fmac_f32 v102, v76, v4
    v_fmac_f32 v103, v76, v5
    v_fmac_f32 v110, v77, v4
    v_fmac_f32 v111, v77, v5
    s_waitcnt vmcnt(4)
    v_lshlrev_b32 v4, 16, v140
    v_and_b32 v5, 0xffff0000, v140
    v_fmac_f32 v96, v78, v4
    v_fmac_f32 v97, v78, v5
    v_fmac_f32 v104, v79, v4
    v_fmac_f32 v105, v79, v5
    v_lshlrev_b32 v4, 16, v141
    v_and_b32 v5, 0xffff0000, v141
    v_fmac_f32 v98, v78, v4
    v_fmac_f32 v99, v78, v5
    v_fmac_f32 v106, v79, v4
    v_fmac_f32 v107, v79, v5
    v_lshlrev_b32 v4, 16, v142
    v_and_b32 v5, 0xffff0000, v142
    v_fmac_f32 v100, v78, v4
    v_fmac_f32 v101, v78, v5
    v_fmac_f32 v108, v79, v4
    v_fmac_f32 v109, v79, v5
    v_lshlrev_b32 v4, 16, v143
    v_and_b32 v5, 0xffff0000, v143
    v_fmac_f32 v102, v78, v4
    v_fmac_f32 v103, v78, v5
    v_fmac_f32 v110, v79, v4
    v_fmac_f32 v111, v79, v5
    s_waitcnt vmcnt(3)
    v_lshlrev_b32 v4, 16, v144
    v_and_b32 v5, 0xffff0000, v144
    v_fmac_f32 v96, v80, v4
    v_fmac_f32 v97, v80, v5
    v_fmac_f32 v104, v81, v4
    v_fmac_f32 v105, v81, v5
    v_lshlrev_b32 v4, 16, v145
    v_and_b32 v5, 0xffff0000, v145
    v_fmac_f32 v98, v80, v4
    v_fmac_f32 v99, v80, v5
    v_fmac_f32 v106, v81, v4
    v_fmac_f32 v107, v81, v5
    v_lshlrev_b32 v4, 16, v146
    v_and_b32 v5, 0xffff0000, v146
    v_fmac_f32 v100, v80, v4
    v_fmac_f32 v101, v80, v5
    v_fmac_f32 v108, v81, v4
    v_fmac_f32 v109, v81, v5
    v_lshlrev_b32 v4, 16, v147
    v_and_b32 v5, 0xffff0000, v147
    v_fmac_f32 v102, v80, v4
    v_fmac_f32 v103, v80, v5
    v_fmac_f32 v110, v81, v4
    v_fmac_f32 v111, v81, v5
    s_waitcnt vmcnt(2)
    v_lshlrev_b32 v4, 16, v148
    v_and_b32 v5, 0xffff0000, v148
    v_fmac_f32 v96, v82, v4
    v_fmac_f32 v97, v82, v5
    v_fmac_f32 v104, v83, v4
    v_fmac_f32 v105, v83, v5
    v_lshlrev_b32 v4, 16, v149
    v_and_b32 v5, 0xffff0000, v149
    v_fmac_f32 v98, v82, v4
    v_fmac_f32 v99, v82, v5
    v_fmac_f32 v106, v83, v4
    v_fmac_f32 v107, v83, v5
    v_lshlrev_b32 v4, 16, v150
    v_and_b32 v5, 0xffff0000, v150
    v_fmac_f32 v100, v82, v4
    v_fmac_f32 v101, v82, v5
    v_fmac_f32 v108, v83, v4
    v_fmac_f32 v109, v83, v5
    v_lshlrev_b32 v4, 16, v151
    v_and_b32 v5, 0xffff0000, v151
    v_fmac_f32 v102, v82, v4
    v_fmac_f32 v103, v82, v5
    v_fmac_f32 v110, v83, v4
    v_fmac_f32 v111, v83, v5
    s_waitcnt vmcnt(1)
    v_lshlrev_b32 v4, 16, v152
    v_and_b32 v5, 0xffff0000, v152
    v_fmac_f32 v96, v84, v4
    v_fmac_f32 v97, v84, v5
    v_fmac_f32 v104, v85, v4
    v_fmac_f32 v105, v85, v5
    v_lshlrev_b32 v4, 16, v153
    v_and_b32 v5, 0xffff0000, v153
    v_fmac_f32 v98, v84, v4
    v_fmac_f32 v99, v84, v5
    v_fmac_f32 v106, v85, v4
    v_fmac_f32 v107, v85, v5
    v_lshlrev_b32 v4, 16, v154
    v_and_b32 v5, 0xffff0000, v154
    v_fmac_f32 v100, v84, v4
    v_fmac_f32 v101, v84, v5
    v_fmac_f32 v108, v85, v4
    v_fmac_f32 v109, v85, v5
    v_lshlrev_b32 v4, 16, v155
    v_and_b32 v5, 0xffff0000, v155
    v_fmac_f32 v102, v84, v4
    v_fmac_f32 v103, v84, v5
    v_fmac_f32 v110, v85, v4
    v_fmac_f32 v111, v85, v5
    s_waitcnt vmcnt(0)
    v_lshlrev_b32 v4, 16, v156
    v_and_b32 v5, 0xffff0000, v156
    v_fmac_f32 v96, v86, v4
    v_fmac_f32 v97, v86, v5
    v_fmac_f32 v104, v87, v4
    v_fmac_f32 v105, v87, v5
    v_lshlrev_b32 v4, 16, v157
    v_and_b32 v5, 0xffff0000, v157
    v_fmac_f32 v98, v86, v4
    v_fmac_f32 v99, v86, v5
    v_fmac_f32 v106, v87, v4
    v_fmac_f32 v107, v87, v5
    v_lshlrev_b32 v4, 16, v158
    v_and_b32 v5, 0xffff0000, v158
    v_fmac_f32 v100, v86, v4
    v_fmac_f32 v101, v86, v5
    v_fmac_f32 v108, v87, v4
    v_fmac_f32 v109, v87, v5
    v_lshlrev_b32 v4, 16, v159
    v_and_b32 v5, 0xffff0000, v159
    v_fmac_f32 v102, v86, v4
    v_fmac_f32 v103, v86, v5
    v_fmac_f32 v110, v87, v4
    v_fmac_f32 v111, v87, v5
    v_lshlrev_b32 v24, 8, v29
    v_lshl_add_u32 v24, v28, 5, v24
    ds_write_b128 v24, v[96:99] offset:6400
    ds_write_b128 v24, v[100:103] offset:6416
    ds_write_b128 v24, v[104:107] offset:6528
    ds_write_b128 v24, v[108:111] offset:6544
    s_waitcnt lgkmcnt(0)
    s_barrier
    v_lshlrev_b32 v24, 12, v2
    v_add_u32 v24, v24, v3
    ds_read_b32 v64, v24 offset:6400
    ds_read_b32 v65, v24 offset:6656
    ds_read_b32 v66, v24 offset:6912
    ds_read_b32 v67, v24 offset:7168
    ds_read_b32 v68, v24 offset:7424
    ds_read_b32 v69, v24 offset:7680
    ds_read_b32 v70, v24 offset:7936
    ds_read_b32 v71, v24 offset:8192
    ds_read_b32 v72, v24 offset:8448
    ds_read_b32 v73, v24 offset:8704
    ds_read_b32 v74, v24 offset:8960
    ds_read_b32 v75, v24 offset:9216
    ds_read_b32 v76, v24 offset:9472
    ds_read_b32 v77, v24 offset:9728
    ds_read_b32 v78, v24 offset:9984
    ds_read_b32 v79, v24 offset:10240
    s_waitcnt lgkmcnt(0)
    v_add_f32 v25, v64, v65
    v_add_f32 v25, v25, v66
    v_add_f32 v25, v25, v67
    v_add_f32 v25, v25, v68
    v_add_f32 v25, v25, v69
    v_add_f32 v25, v25, v70
    v_add_f32 v25, v25, v71
    v_add_f32 v25, v25, v72
    v_add_f32 v25, v25, v73
    v_add_f32 v25, v25, v74
    v_add_f32 v25, v25, v75
    v_add_f32 v25, v25, v76
    v_add_f32 v25, v25, v77
    v_add_f32 v25, v25, v78
    v_add_f32 v25, v25, v79
    v_lshlrev_b32 v24, 2, v0
    ds_write_b32 v24, v25 offset:22784
    s_waitcnt lgkmcnt(0)
    s_barrier
    v_cmp_gt_u32 vcc, 64, v0
    s_and_saveexec_b64 s[22:23], vcc
    s_cbranch_execz kt_done
    ds_read_b32 v64, v3 offset:22784
    ds_read_b32 v65, v3 offset:23040
    ds_read_b32 v66, v3 offset:23296
    ds_read_b32 v67, v3 offset:23552
    s_waitcnt lgkmcnt(0)
    v_add_f32 v25, v64, v65
    v_add_f32 v25, v25, v66
    v_add_f32 v25, v25, v67
    v_lshrrev_b32 v26, 5, v1
    v_mul_u32_u24 v26, 2560, v26
    v_and_b32 v27, 31, v1
    v_lshl_add_u32 v26, v27, 2, v26
    s_mul_i32 s27, s20, 5120
    s_lshl_b32 s28, s21, 7
    s_add_u32 s27, s27, s28
    s_add_u32 s27, s27, 1048576
    buffer_store_dword v25, v26, s[16:19], s27 offen sc1
    s_endpgm
kt_role_c:
    s_sub_u32 s2, s2, 160
    s_load_dwordx2 s[8:9], s[0:1], 0
    s_load_dwordx2 s[12:13], s[0:1], 48
    s_load_dwordx2 s[16:17], s[0:1], 88
    s_load_dwordx2 s[20:21], s[0:1], 56
    s_load_dwordx2 s[24:25], s[0:1], 64
    s_load_dwordx2 s[60:61], s[0:1], 80
    s_waitcnt lgkmcnt(0)
    s_and_b32 s9, s9, 0xffff
    s_mov_b32 s10, 2560
    s_mov_b32 s11, 0x00020000
    s_and_b32 s13, s13, 0xffff
    s_mov_b32 s14, 1966080
    s_mov_b32 s15, 0x00020000
    s_and_b32 s17, s17, 0xffff
    s_mov_b32 s18, 805306368
    s_mov_b32 s19, 0x00020000
    s_and_b32 s21, s21, 0xffff
    s_mov_b32 s22, 1966080
    s_mov_b32 s23, 0x00020000
    s_and_b32 s25, s25, 0xffff
    s_mov_b32 s26, 1966080
    s_mov_b32 s27, 0x00020000
    s_and_b32 s61, s61, 0xffff
    s_mov_b32 s62, 256
    s_mov_b32 s63, 0x00020000
    v_and_b32 v1, 63, v0
    v_lshrrev_b32 v2, 6, v0
    v_lshlrev_b32 v3, 2, v1
    s_and_b32 s40, s2, 7
    s_mul_i32 s40, s40, 12
    s_lshr_b32 s41, s2, 3
    s_add_u32 s40, s40, s41
    v_and_b32 v6, 1, v2
    v_mul_u32_u24 v7, 1280, v6
    v_add_u32 v7, v7, v3
    v_lshlrev_b32 v27, 1, v7
    v_and_b32 v28, 1, v0
    v_lshrrev_b32 v29, 1, v0
    v_mul_u32_u24 v30, 3072, v29
    v_lshl_add_u32 v30, v28, 4, v30
    s_lshl_b32 s43, s40, 5
    buffer_load_dwordx4 v[32:35], v30, s[12:15], s43 offen nt
    buffer_load_dwordx4 v[52:55], v30, s[20:23], s43 offen nt
    s_add_u32 s43, s43, 393216
    buffer_load_dwordx4 v[36:39], v30, s[12:15], s43 offen nt
    buffer_load_dwordx4 v[56:59], v30, s[20:23], s43 offen nt
    s_add_u32 s43, s43, 393216
    buffer_load_dwordx4 v[40:43], v30, s[12:15], s43 offen nt
    buffer_load_dwordx4 v[60:63], v30, s[20:23], s43 offen nt
    s_add_u32 s43, s43, 393216
    buffer_load_dwordx4 v[44:47], v30, s[12:15], s43 offen nt
    buffer_load_dwordx4 v[64:67], v30, s[20:23], s43 offen nt
    s_add_u32 s43, s43, 393216
    buffer_load_dwordx4 v[48:51], v30, s[12:15], s43 offen nt
    buffer_load_dwordx4 v[68:71], v30, s[20:23], s43 offen nt
    v_mul_u32_u24 v31, 205, v0
    v_lshrrev_b32 v31, 14, v31
    v_mul_u32_u24 v98, 80, v31
    v_sub_u32 v98, v0, v98
    v_mul_u32_u24 v99, 1280, v31
    v_lshl_add_u32 v99, v98, 4, v99
    s_mul_i32 s43, s40, 20480
    buffer_load_dwordx4 v[72:75], v99, s[24:27], s43 offen nt
    s_add_u32 s43, s43, 3840
    buffer_load_dwordx4 v[76:79], v99, s[24:27], s43 offen nt
    s_add_u32 s43, s43, 3840
    buffer_load_dwordx4 v[80:83], v99, s[24:27], s43 offen nt
    s_add_u32 s43, s43, 3840
    buffer_load_dwordx4 v[84:87], v99, s[24:27], s43 offen nt
    s_add_u32 s43, s43, 3840
    buffer_load_dwordx4 v[88:91], v99, s[24:27], s43 offen nt
    s_add_u32 s43, s43, 3840
    buffer_load_dwordx4 v[92:95], v99, s[24:27], s43 offen nt
    v_readfirstlane_b32 s48, v2
    s_cmp_ge_u32 s48, 2
    s_cbranch_scc1 kc_noln
    s_mov_b32 s58, 0
    buffer_load_dword v8, v7, s[8:11], 0 offen offset:0
    buffer_load_dword v9, v7, s[8:11], 0 offen offset:256
    buffer_load_dword v10, v7, s[8:11], 0 offen offset:512
    buffer_load_dword v11, v7, s[8:11], 0 offen offset:768
    buffer_load_dword v12, v7, s[8:11], 0 offen offset:1024
kc_poll:
    s_mov_b32 s42, 1048576
    buffer_load_dwordx2 v[164:165], v27, s[16:19], s42 offen offset:0 sc1
    buffer_load_dwordx2 v[166:167], v27, s[16:19], s42 offen offset:512 sc1
    buffer_load_dwordx2 v[168:169], v27, s[16:19], s42 offen offset:1024 sc1
    buffer_load_dwordx2 v[170:171], v27, s[16:19], s42 offen offset:1536 sc1
    buffer_load_dwordx2 v[172:173], v27, s[16:19], s42 offen offset:2048 sc1
    s_add_u32 s42, s42, 5120
    buffer_load_dwordx2 v[174:175], v27, s[16:19], s42 offen offset:0 sc1
    buffer_load_dwordx2 v[176:177], v27, s[16:19], s42 offen offset:512 sc1
    buffer_load_dwordx2 v[178:179], v27, s[16:19], s42 offen offset:1024 sc1
    buffer_load_dwordx2 v[180:181], v27, s[16:19], s42 offen offset:1536 sc1
    buffer_load_dwordx2 v[182:183], v27, s[16:19], s42 offen offset:2048 sc1
    s_add_u32 s42, s42, 5120
    buffer_load_dwordx2 v[184:185], v27, s[16:19], s42 offen offset:0 sc1
    buffer_load_dwordx2 v[186:187], v27, s[16:19], s42 offen offset:512 sc1
    buffer_load_dwordx2 v[188:189], v27, s[16:19], s42 offen offset:1024 sc1
    buffer_load_dwordx2 v[190:191], v27, s[16:19], s42 offen offset:1536 sc1
    buffer_load_dwordx2 v[192:193], v27, s[16:19], s42 offen offset:2048 sc1
    s_add_u32 s42, s42, 5120
    buffer_load_dwordx2 v[194:195], v27, s[16:19], s42 offen offset:0 sc1
    buffer_load_dwordx2 v[196:197], v27, s[16:19], s42 offen offset:512 sc1
    buffer_load_dwordx2 v[198:199], v27, s[16:19], s42 offen offset:1024 sc1
    buffer_load_dwordx2 v[200:201], v27, s[16:19], s42 offen offset:1536 sc1
    buffer_load_dwordx2 v[202:203], v27, s[16:19], s42 offen offset:2048 sc1
    s_add_u32 s42, s42, 5120
    buffer_load_dwordx2 v[204:205], v27, s[16:19], s42 offen offset:0 sc1
    buffer_load_dwordx2 v[206:207], v27, s[16:19], s42 offen offset:512 sc1
    buffer_load_dwordx2 v[208:209], v27, s[16:19], s42 offen offset:1024 sc1
    buffer_load_dwordx2 v[210:211], v27, s[16:19], s42 offen offset:1536 sc1
    buffer_load_dwordx2 v[212:213], v27, s[16:19], s42 offen offset:2048 sc1
    s_add_u32 s42, s42, 5120
    buffer_load_dwordx2 v[214:215], v27, s[16:19], s42 offen offset:0 sc1
    buffer_load_dwordx2 v[216:217], v27, s[16:19], s42 offen offset:512 sc1
    buffer_load_dwordx2 v[218:219], v27, s[16:19], s42 offen offset:1024 sc1
    buffer_load_dwordx2 v[220:221], v27, s[16:19], s42 offen offset:1536 sc1
    buffer_load_dwordx2 v[222:223], v27, s[16:19], s42 offen offset:2048 sc1
    s_add_u32 s42, s42, 5120
    buffer_load_dwordx2 v[224:225], v27, s[16:19], s42 offen offset:0 sc1
    buffer_load_dwordx2 v[226:227], v27, s[16:19], s42 offen offset:512 sc1
    buffer_load_dwordx2 v[228:229], v27, s[16:19], s42 offen offset:1024 sc1
    buffer_load_dwordx2 v[230:231], v27, s[16:19], s42 offen offset:1536 sc1
    buffer_load_dwordx2 v[232:233], v27, s[16:19], s42 offen offset:2048 sc1
    s_add_u32 s42, s42, 5120
    buffer_load_dwordx2 v[234:235], v27, s[16:19], s42 offen offset:0 sc1
    buffer_load_dwordx2 v[236:237], v27, s[16:19], s42 offen offset:512 sc1
    buffer_load_dwordx2 v[238:239], v27, s[16:19], s42 offen offset:1024 sc1
    buffer_load_dwordx2 v[240:241], v27, s[16:19], s42 offen offset:1536 sc1
    buffer_load_dwordx2 v[242:243], v27, s[16:19], s42 offen offset:2048 sc1
    s_waitcnt vmcnt(0)
    v_max_u32 v100, v164, v165
    v_max3_u32 v100, v100, v166, v167
    v_max3_u32 v100, v100, v168, v169
    v_max3_u32 v100, v100, v170, v171
    v_max3_u32 v100, v100, v172, v173
    v_max3_u32 v100, v100, v174, v175
    v_max3_u32 v100, v100, v176, v177
    v_max3_u32 v100, v100, v178, v179
    v_max3_u32 v100, v100, v180, v181
    v_max3_u32 v100, v100, v182, v183
    v_max3_u32 v100, v100, v184, v185
    v_max3_u32 v100, v100, v186, v187
    v_max3_u32 v100, v100, v188, v189
    v_max3_u32 v100, v100, v190, v191
    v_max3_u32 v100, v100, v192, v193
    v_max3_u32 v100, v100, v194, v195
    v_max3_u32 v100, v100, v196, v197
    v_max3_u32 v100, v100, v198, v199
    v_max3_u32 v100, v100, v200, v201
    v_max3_u32 v100, v100, v202, v203
    v_max3_u32 v100, v100, v204, v205
    v_max3_u32 v100, v100, v206, v207
    v_max3_u32 v100, v100, v208, v209
    v_max3_u32 v100, v100, v210, v211
    v_max3_u32 v100, v100, v212, v213
    v_max3_u32 v100, v100, v214, v215
    v_max3_u32 v100, v100, v216, v217
    v_max3_u32 v100, v100, v218, v219
    v_max3_u32 v100, v100, v220, v221
    v_max3_u32 v100, v100, v222, v223
    v_max3_u32 v100, v100, v224, v225
    v_max3_u32 v100, v100, v226, v227
    v_max3_u32 v100, v100, v228, v229
    v_max3_u32 v100, v100, v230, v231
    v_max3_u32 v100, v100, v232, v233
    v_max3_u32 v100, v100, v234, v235
    v_max3_u32 v100, v100, v236, v237
    v_max3_u32 v100, v100, v238, v239
    v_max3_u32 v100, v100, v240, v241
    v_max3_u32 v100, v100, v242, v243
    v_cmp_eq_u32 vcc, -1, v100
    s_add_u32 s58, s58, 1
    s_nop 1
    s_cbranch_vccz kc_poll_ok
    s_sleep 1
    s_cmp_lt_u32 s58, 0x10000
    s_cbranch_scc1 kc_poll
kc_poll_ok:
    v_lshlrev_b32 v14, 16, v8
    v_and_b32 v15, 0xffff0000, v8
    v_lshlrev_b32 v16, 16, v9
    v_and_b32 v17, 0xffff0000, v9
    v_lshlrev_b32 v18, 16, v10
    v_and_b32 v19, 0xffff0000, v10
    v_lshlrev_b32 v20, 16, v11
    v_and_b32 v21, 0xffff0000, v11
    v_lshlrev_b32 v22, 16, v12
    v_and_b32 v23, 0xffff0000, v12
    v_add_f32 v164, v164, v174
    v_add_f32 v164, v164, v184
    v_add_f32 v164, v164, v194
    v_add_f32 v164, v164, v204
    v_add_f32 v164, v164, v214
    v_add_f32 v164, v164, v224
    v_add_f32 v164, v164, v234
    v_cvt_pk_bf16_f32 v164, v164, v164
    v_lshlrev_b32 v164, 16, v164
    v_add_f32 v14, v14, v164
    v_cvt_pk_bf16_f32 v14, v14, v14
    v_lshlrev_b32 v14, 16, v14
    v_add_f32 v165, v165, v175
    v_add_f32 v165, v165, v185
    v_add_f32 v165, v165, v195
    v_add_f32 v165, v165, v205
    v_add_f32 v165, v165, v215
    v_add_f32 v165, v165, v225
    v_add_f32 v165, v165, v235
    v_cvt_pk_bf16_f32 v165, v165, v165
    v_lshlrev_b32 v165, 16, v165
    v_add_f32 v15, v15, v165
    v_cvt_pk_bf16_f32 v15, v15, v15
    v_lshlrev_b32 v15, 16, v15
    v_add_f32 v166, v166, v176
    v_add_f32 v166, v166, v186
    v_add_f32 v166, v166, v196
    v_add_f32 v166, v166, v206
    v_add_f32 v166, v166, v216
    v_add_f32 v166, v166, v226
    v_add_f32 v166, v166, v236
    v_cvt_pk_bf16_f32 v166, v166, v166
    v_lshlrev_b32 v166, 16, v166
    v_add_f32 v16, v16, v166
    v_cvt_pk_bf16_f32 v16, v16, v16
    v_lshlrev_b32 v16, 16, v16
    v_add_f32 v167, v167, v177
    v_add_f32 v167, v167, v187
    v_add_f32 v167, v167, v197
    v_add_f32 v167, v167, v207
    v_add_f32 v167, v167, v217
    v_add_f32 v167, v167, v227
    v_add_f32 v167, v167, v237
    v_cvt_pk_bf16_f32 v167, v167, v167
    v_lshlrev_b32 v167, 16, v167
    v_add_f32 v17, v17, v167
    v_cvt_pk_bf16_f32 v17, v17, v17
    v_lshlrev_b32 v17, 16, v17
    v_add_f32 v168, v168, v178
    v_add_f32 v168, v168, v188
    v_add_f32 v168, v168, v198
    v_add_f32 v168, v168, v208
    v_add_f32 v168, v168, v218
    v_add_f32 v168, v168, v228
    v_add_f32 v168, v168, v238
    v_cvt_pk_bf16_f32 v168, v168, v168
    v_lshlrev_b32 v168, 16, v168
    v_add_f32 v18, v18, v168
    v_cvt_pk_bf16_f32 v18, v18, v18
    v_lshlrev_b32 v18, 16, v18
    v_add_f32 v169, v169, v179
    v_add_f32 v169, v169, v189
    v_add_f32 v169, v169, v199
    v_add_f32 v169, v169, v209
    v_add_f32 v169, v169, v219
    v_add_f32 v169, v169, v229
    v_add_f32 v169, v169, v239
    v_cvt_pk_bf16_f32 v169, v169, v169
    v_lshlrev_b32 v169, 16, v169
    v_add_f32 v19, v19, v169
    v_cvt_pk_bf16_f32 v19, v19, v19
    v_lshlrev_b32 v19, 16, v19
    v_add_f32 v170, v170, v180
    v_add_f32 v170, v170, v190
    v_add_f32 v170, v170, v200
    v_add_f32 v170, v170, v210
    v_add_f32 v170, v170, v220
    v_add_f32 v170, v170, v230
    v_add_f32 v170, v170, v240
    v_cvt_pk_bf16_f32 v170, v170, v170
    v_lshlrev_b32 v170, 16, v170
    v_add_f32 v20, v20, v170
    v_cvt_pk_bf16_f32 v20, v20, v20
    v_lshlrev_b32 v20, 16, v20
    v_add_f32 v171, v171, v181
    v_add_f32 v171, v171, v191
    v_add_f32 v171, v171, v201
    v_add_f32 v171, v171, v211
    v_add_f32 v171, v171, v221
    v_add_f32 v171, v171, v231
    v_add_f32 v171, v171, v241
    v_cvt_pk_bf16_f32 v171, v171, v171
    v_lshlrev_b32 v171, 16, v171
    v_add_f32 v21, v21, v171
    v_cvt_pk_bf16_f32 v21, v21, v21
    v_lshlrev_b32 v21, 16, v21
    v_add_f32 v172, v172, v182
    v_add_f32 v172, v172, v192
    v_add_f32 v172, v172, v202
    v_add_f32 v172, v172, v212
    v_add_f32 v172, v172, v222
    v_add_f32 v172, v172, v232
    v_add_f32 v172, v172, v242
    v_cvt_pk_bf16_f32 v172, v172, v172
    v_lshlrev_b32 v172, 16, v172
    v_add_f32 v22, v22, v172
    v_cvt_pk_bf16_f32 v22, v22, v22
    v_lshlrev_b32 v22, 16, v22
    v_add_f32 v173, v173, v183
    v_add_f32 v173, v173, v193
    v_add_f32 v173, v173, v203
    v_add_f32 v173, v173, v213
    v_add_f32 v173, v173, v223
    v_add_f32 v173, v173, v233
    v_add_f32 v173, v173, v243
    v_cvt_pk_bf16_f32 v173, v173, v173
    v_lshlrev_b32 v173, 16, v173
    v_add_f32 v23, v23, v173
    v_cvt_pk_bf16_f32 v23, v23, v23
    v_lshlrev_b32 v23, 16, v23
    s_cmp_lg_u32 s2, 0
    s_cbranch_scc1 kc_noh
    s_mov_b32 s42, 1089536
    buffer_store_dwordx2 v[14:15], v27, s[16:19], s42 offen offset:0 sc1
    buffer_store_dwordx2 v[16:17], v27, s[16:19], s42 offen offset:512 sc1
    buffer_store_dwordx2 v[18:19], v27, s[16:19], s42 offen offset:1024 sc1
    buffer_store_dwordx2 v[20:21], v27, s[16:19], s42 offen offset:1536 sc1
    buffer_store_dwordx2 v[22:23], v27, s[16:19], s42 offen offset:2048 sc1
    s_waitcnt vmcnt(0)
kc_noh:
    v_add_f32 v24, v14, v15
    v_add_f32 v24, v24, v16
    v_add_f32 v24, v24, v17
    v_add_f32 v24, v24, v18
    v_add_f32 v24, v24, v19
    v_add_f32 v24, v24, v20
    v_add_f32 v24, v24, v21
    v_add_f32 v24, v24, v22
    v_add_f32 v24, v24, v23
    s_nop 1
    v_add_f32_dpp v24, v24, v24 row_ror:1 row_mask:0xf bank_mask:0xf
    s_nop 1
    v_add_f32_dpp v24, v24, v24 row_ror:2 row_mask:0xf bank_mask:0xf
    s_nop 1
    v_add_f32_dpp v24, v24, v24 row_ror:4 row_mask:0xf bank_mask:0xf
    s_nop 1
    v_add_f32_dpp v24, v24, v24 row_ror:8 row_mask:0xf bank_mask:0xf
    s_nop 0
    v_readlane_b32 s52, v24, 0
    v_readlane_b32 s53, v24, 16
    v_readlane_b32 s54, v24, 32
    v_readlane_b32 s55, v24, 48
    s_nop 1
    v_mov_b32 v24, s52
    v_add_f32 v24, s53, v24
    v_add_f32 v24, s54, v24
    v_add_f32 v24, s55, v24
    v_mul_f32 v24, 0.0015625, v24
    v_sub_f32 v26, v14, v24
    v_mul_f32 v25, v26, v26
    v_sub_f32 v26, v15, v24
    v_fmac_f32 v25, v26, v26
    v_sub_f32 v26, v16, v24
    v_fmac_f32 v25, v26, v26
    v_sub_f32 v26, v17, v24
    v_fmac_f32 v25, v26, v26
    v_sub_f32 v26, v18, v24
    v_fmac_f32 v25, v26, v26
    v_sub_f32 v26, v19, v24
    v_fmac_f32 v25, v26, v26
    v_sub_f32 v26, v20, v24
    v_fmac_f32 v25, v26, v26
    v_sub_f32 v26, v21, v24
    v_fmac_f32 v25, v26, v26
    v_sub_f32 v26, v22, v24
    v_fmac_f32 v25, v26, v26
    v_sub_f32 v26, v23, v24
    v_fmac_f32 v25, v26, v26
    s_nop 1
    v_add_f32_dpp v25, v25, v25 row_ror:1 row_mask:0xf bank_mask:0xf
    s_nop 1
    v_add_f32_dpp v25, v25, v25 row_ror:2 row_mask:0xf bank_mask:0xf
    s_nop 1
    v_add_f32_dpp v25, v25, v25 row_ror:4 row_mask:0xf bank_mask:0xf
    s_nop 1
    v_add_f32_dpp v25, v25, v25 row_ror:8 row_mask:0xf bank_mask:0xf
    s_nop 0
    v_readlane_b32 s52, v25, 0
    v_readlane_b32 s53, v25, 16
    v_readlane_b32 s54, v25, 32
    v_readlane_b32 s55, v25, 48
    s_nop 1
    v_mov_b32 v25, s52
    v_add_f32 v25, s53, v25
    v_add_f32 v25, s54, v25
    v_add_f32 v25, s55, v25
    v_mul_f32 v25, 0.0015625, v25
    v_cvt_pk_bf16_f32 v24, v24, v24
    v_lshlrev_b32 v24, 16, v24
    v_cvt_pk_bf16_f32 v25, v25, v25
    v_lshlrev_b32 v25, 16, v25
    v_add_f32 v25, 1e-05, v25
    v_cvt_pk_bf16_f32 v25, v25, v25
    v_lshlrev_b32 v25, 16, v25
    v_sqrt_f32 v25, v25
    s_nop 0
    v_cvt_pk_bf16_f32 v25, v25, v25
    v_lshlrev_b32 v25, 16, v25
    v_rcp_f32 v25, v25
    s_nop 0
    v_sub_f32 v14, v14, v24
    v_cvt_pk_bf16_f32 v14, v14, v14
    v_lshlrev_b32 v14, 16, v14
    v_mul_f32 v14, v14, v25
    v_cvt_pk_bf16_f32 v14, v14, v14
    v_lshlrev_b32 v14, 16, v14
    v_sub_f32 v15, v15, v24
    v_cvt_pk_bf16_f32 v15, v15, v15
    v_lshlrev_b32 v15, 16, v15
    v_mul_f32 v15, v15, v25
    v_cvt_pk_bf16_f32 v15, v15, v15
    v_lshlrev_b32 v15, 16, v15
    v_sub_f32 v16, v16, v24
    v_cvt_pk_bf16_f32 v16, v16, v16
    v_lshlrev_b32 v16, 16, v16
    v_mul_f32 v16, v16, v25
    v_cvt_pk_bf16_f32 v16, v16, v16
    v_lshlrev_b32 v16, 16, v16
    v_sub_f32 v17, v17, v24
    v_cvt_pk_bf16_f32 v17, v17, v17
    v_lshlrev_b32 v17, 16, v17
    v_mul_f32 v17, v17, v25
    v_cvt_pk_bf16_f32 v17, v17, v17
    v_lshlrev_b32 v17, 16, v17
    v_sub_f32 v18, v18, v24
    v_cvt_pk_bf16_f32 v18, v18, v18
    v_lshlrev_b32 v18, 16, v18
    v_mul_f32 v18, v18, v25
    v_cvt_pk_bf16_f32 v18, v18, v18
    v_lshlrev_b32 v18, 16, v18
    v_sub_f32 v19, v19, v24
    v_cvt_pk_bf16_f32 v19, v19, v19
    v_lshlrev_b32 v19, 16, v19
    v_mul_f32 v19, v19, v25
    v_cvt_pk_bf16_f32 v19, v19, v19
    v_lshlrev_b32 v19, 16, v19
    v_sub_f32 v20, v20, v24
    v_cvt_pk_bf16_f32 v20, v20, v20
    v_lshlrev_b32 v20, 16, v20
    v_mul_f32 v20, v20, v25
    v_cvt_pk_bf16_f32 v20, v20, v20
    v_lshlrev_b32 v20, 16, v20
    v_sub_f32 v21, v21, v24
    v_cvt_pk_bf16_f32 v21, v21, v21
    v_lshlrev_b32 v21, 16, v21
    v_mul_f32 v21, v21, v25
    v_cvt_pk_bf16_f32 v21, v21, v21
    v_lshlrev_b32 v21, 16, v21
    v_sub_f32 v22, v22, v24
    v_cvt_pk_bf16_f32 v22, v22, v22
    v_lshlrev_b32 v22, 16, v22
    v_mul_f32 v22, v22, v25
    v_cvt_pk_bf16_f32 v22, v22, v22
    v_lshlrev_b32 v22, 16, v22
    v_sub_f32 v23, v23, v24
    v_cvt_pk_bf16_f32 v23, v23, v23
    v_lshlrev_b32 v23, 16, v23
    v_mul_f32 v23, v23, v25
    v_cvt_pk_bf16_f32 v23, v23, v23
    v_lshlrev_b32 v23, 16, v23
    v_lshlrev_b32 v24, 4, v1
    v_lshl_add_u32 v24, v6, 2, v24
    ds_write_b32 v24, v14 offset:0
    ds_write_b32 v24, v15 offset:8
    ds_write_b32 v24, v16 offset:1024
    ds_write_b32 v24, v17 offset:1032
    ds_write_b32 v24, v18 offset:2048
    ds_write_b32 v24, v19 offset:2056
    ds_write_b32 v24, v20 offset:3072
    ds_write_b32 v24, v21 offset:3080
    ds_write_b32 v24, v22 offset:4096
    ds_write_b32 v24, v23 offset:4104
kc_noln:
    s_waitcnt lgkmcnt(0)
    s_barrier
    v_lshlrev_b32 v24, 3, v29
    ds_read_b64 v[120:121], v24 offset:0
    ds_read_b64 v[122:123], v24 offset:1024
    ds_read_b64 v[124:125], v24 offset:2048
    ds_read_b64 v[126:127], v24 offset:3072
    ds_read_b64 v[128:129], v24 offset:4096
    v_mov_b32 v132, 0
    v_mov_b32 v133, 0
    v_mov_b32 v134, 0
    v_mov_b32 v135, 0
    v_mov_b32 v136, 0
    v_mov_b32 v137, 0
    v_mov_b32 v138, 0
    v_mov_b32 v139, 0
    v_mov_b32 v140, 0
    v_mov_b32 v141, 0
    v_mov_b32 v142, 0
    v_mov_b32 v143, 0
    v_mov_b32 v144, 0
    v_mov_b32 v145, 0
    v_mov_b32 v146, 0
    v_mov_b32 v147, 0
    v_mov_b32 v148, 0
    v_mov_b32 v149, 0
    v_mov_b32 v150, 0
    v_mov_b32 v151, 0
    v_mov_b32 v152, 0
    v_mov_b32 v153, 0
    v_mov_b32 v154, 0
    v_mov_b32 v155, 0
    v_mov_b32 v156, 0
    v_mov_b32 v157, 0
    v_mov_b32 v158, 0
    v_mov_b32 v159, 0
    v_mov_b32 v160, 0
    v_mov_b32 v161, 0
    v_mov_b32 v162, 0
    v_mov_b32 v163, 0
    s_waitcnt lgkmcnt(0)
    s_waitcnt vmcnt(15)
    v_lshlrev_b32 v4, 16, v32
    v_and_b32 v5, 0xffff0000, v32
    v_fmac_f32 v132, v120, v4
    v_fmac_f32 v133, v120, v5
    v_fmac_f32 v140, v121, v4
    v_fmac_f32 v141, v121, v5
    v_lshlrev_b32 v4, 16, v33
    v_and_b32 v5, 0xffff0000, v33
    v_fmac_f32 v134, v120, v4
    v_fmac_f32 v135, v120, v5
    v_fmac_f32 v142, v121, v4
    v_fmac_f32 v143, v121, v5
    v_lshlrev_b32 v4, 16, v34
    v_and_b32 v5, 0xffff0000, v34
    v_fmac_f32 v136, v120, v4
    v_fmac_f32 v137, v120, v5
    v_fmac_f32 v144, v121, v4
    v_fmac_f32 v145, v121, v5
    v_lshlrev_b32 v4, 16, v35
    v_and_b32 v5, 0xffff0000, v35
    v_fmac_f32 v138, v120, v4
    v_fmac_f32 v139, v120, v5
    v_fmac_f32 v146, v121, v4
    v_fmac_f32 v147, v121, v5
    s_waitcnt vmcnt(14)
    v_lshlrev_b32 v4, 16, v52
    v_and_b32 v5, 0xffff0000, v52
    v_fmac_f32 v148, v120, v4
    v_fmac_f32 v149, v120, v5
    v_fmac_f32 v156, v121, v4
    v_fmac_f32 v157, v121, v5
    v_lshlrev_b32 v4, 16, v53
    v_and_b32 v5, 0xffff0000, v53
    v_fmac_f32 v150, v120, v4
    v_fmac_f32 v151, v120, v5
    v_fmac_f32 v158, v121, v4
    v_fmac_f32 v159, v121, v5
    v_lshlrev_b32 v4, 16, v54
    v_and_b32 v5, 0xffff0000, v54
    v_fmac_f32 v152, v120, v4
    v_fmac_f32 v153, v120, v5
    v_fmac_f32 v160, v121, v4
    v_fmac_f32 v161, v121, v5
    v_lshlrev_b32 v4, 16, v55
    v_and_b32 v5, 0xffff0000, v55
    v_fmac_f32 v154, v120, v4
    v_fmac_f32 v155, v120, v5
    v_fmac_f32 v162, v121, v4
    v_fmac_f32 v163, v121, v5
    s_waitcnt vmcnt(13)
    v_lshlrev_b32 v4, 16, v36
    v_and_b32 v5, 0xffff0000, v36
    v_fmac_f32 v132, v122, v4
    v_fmac_f32 v133, v122, v5
    v_fmac_f32 v140, v123, v4
    v_fmac_f32 v141, v123, v5
    v_lshlrev_b32 v4, 16, v37
    v_and_b32 v5, 0xffff0000, v37
    v_fmac_f32 v134, v122, v4
    v_fmac_f32 v135, v122, v5
    v_fmac_f32 v142, v123, v4
    v_fmac_f32 v143, v123, v5
    v_lshlrev_b32 v4, 16, v38
    v_and_b32 v5, 0xffff0000, v38
    v_fmac_f32 v136, v122, v4
    v_fmac_f32 v137, v122, v5
    v_fmac_f32 v144, v123, v4
    v_fmac_f32 v145, v123, v5
    v_lshlrev_b32 v4, 16, v39
    v_and_b32 v5, 0xffff0000, v39
    v_fmac_f32 v138, v122, v4
    v_fmac_f32 v139, v122, v5
    v_fmac_f32 v146, v123, v4
    v_fmac_f32 v147, v123, v5
    s_waitcnt vmcnt(12)
    v_lshlrev_b32 v4, 16, v56
    v_and_b32 v5, 0xffff0000, v56
    v_fmac_f32 v148, v122, v4
    v_fmac_f32 v149, v122, v5
    v_fmac_f32 v156, v123, v4
    v_fmac_f32 v157, v123, v5
    v_lshlrev_b32 v4, 16, v57
    v_and_b32 v5, 0xffff0000, v57
    v_fmac_f32 v150, v122, v4
    v_fmac_f32 v151, v122, v5
    v_fmac_f32 v158, v123, v4
    v_fmac_f32 v159, v123, v5
    v_lshlrev_b32 v4, 16, v58
    v_and_b32 v5, 0xffff0000, v58
    v_fmac_f32 v152, v122, v4
    v_fmac_f32 v153, v122, v5
    v_fmac_f32 v160, v123, v4
    v_fmac_f32 v161, v123, v5
    v_lshlrev_b32 v4, 16, v59
    v_and_b32 v5, 0xffff0000, v59
    v_fmac_f32 v154, v122, v4
    v_fmac_f32 v155, v122, v5
    v_fmac_f32 v162, v123, v4
    v_fmac_f32 v163, v123, v5
    s_waitcnt vmcnt(11)
    v_lshlrev_b32 v4, 16, v40
    v_and_b32 v5, 0xffff0000, v40
    v_fmac_f32 v132, v124, v4
    v_fmac_f32 v133, v124, v5
    v_fmac_f32 v140, v125, v4
    v_fmac_f32 v141, v125, v5
    v_lshlrev_b32 v4, 16, v41
    v_and_b32 v5, 0xffff0000, v41
    v_fmac_f32 v134, v124, v4
    v_fmac_f32 v135, v124, v5
    v_fmac_f32 v142, v125, v4
    v_fmac_f32 v143, v125, v5
    v_lshlrev_b32 v4, 16, v42
    v_and_b32 v5, 0xffff0000, v42
    v_fmac_f32 v136, v124, v4
    v_fmac_f32 v137, v124, v5
    v_fmac_f32 v144, v125, v4
    v_fmac_f32 v145, v125, v5
    v_lshlrev_b32 v4, 16, v43
    v_and_b32 v5, 0xffff0000, v43
    v_fmac_f32 v138, v124, v4
    v_fmac_f32 v139, v124, v5
    v_fmac_f32 v146, v125, v4
    v_fmac_f32 v147, v125, v5
    s_waitcnt vmcnt(10)
    v_lshlrev_b32 v4, 16, v60
    v_and_b32 v5, 0xffff0000, v60
    v_fmac_f32 v148, v124, v4
    v_fmac_f32 v149, v124, v5
    v_fmac_f32 v156, v125, v4
    v_fmac_f32 v157, v125, v5
    v_lshlrev_b32 v4, 16, v61
    v_and_b32 v5, 0xffff0000, v61
    v_fmac_f32 v150, v124, v4
    v_fmac_f32 v151, v124, v5
    v_fmac_f32 v158, v125, v4
    v_fmac_f32 v159, v125, v5
    v_lshlrev_b32 v4, 16, v62
    v_and_b32 v5, 0xffff0000, v62
    v_fmac_f32 v152, v124, v4
    v_fmac_f32 v153, v124, v5
    v_fmac_f32 v160, v125, v4
    v_fmac_f32 v161, v125, v5
    v_lshlrev_b32 v4, 16, v63
    v_and_b32 v5, 0xffff0000, v63
    v_fmac_f32 v154, v124, v4
    v_fmac_f32 v155, v124, v5
    v_fmac_f32 v162, v125, v4
    v_fmac_f32 v163, v125, v5
    s_waitcnt vmcnt(9)
    v_lshlrev_b32 v4, 16, v44
    v_and_b32 v5, 0xffff0000, v44
    v_fmac_f32 v132, v126, v4
    v_fmac_f32 v133, v126, v5
    v_fmac_f32 v140, v127, v4
    v_fmac_f32 v141, v127, v5
    v_lshlrev_b32 v4, 16, v45
    v_and_b32 v5, 0xffff0000, v45
    v_fmac_f32 v134, v126, v4
    v_fmac_f32 v135, v126, v5
    v_fmac_f32 v142, v127, v4
    v_fmac_f32 v143, v127, v5
    v_lshlrev_b32 v4, 16, v46
    v_and_b32 v5, 0xffff0000, v46
    v_fmac_f32 v136, v126, v4
    v_fmac_f32 v137, v126, v5
    v_fmac_f32 v144, v127, v4
    v_fmac_f32 v145, v127, v5
    v_lshlrev_b32 v4, 16, v47
    v_and_b32 v5, 0xffff0000, v47
    v_fmac_f32 v138, v126, v4
    v_fmac_f32 v139, v126, v5
    v_fmac_f32 v146, v127, v4
    v_fmac_f32 v147, v127, v5
    s_waitcnt vmcnt(8)
    v_lshlrev_b32 v4, 16, v64
    v_and_b32 v5, 0xffff0000, v64
    v_fmac_f32 v148, v126, v4
    v_fmac_f32 v149, v126, v5
    v_fmac_f32 v156, v127, v4
    v_fmac_f32 v157, v127, v5
    v_lshlrev_b32 v4, 16, v65
    v_and_b32 v5, 0xffff0000, v65
    v_fmac_f32 v150, v126, v4
    v_fmac_f32 v151, v126, v5
    v_fmac_f32 v158, v127, v4
    v_fmac_f32 v159, v127, v5
    v_lshlrev_b32 v4, 16, v66
    v_and_b32 v5, 0xffff0000, v66
    v_fmac_f32 v152, v126, v4
    v_fmac_f32 v153, v126, v5
    v_fmac_f32 v160, v127, v4
    v_fmac_f32 v161, v127, v5
    v_lshlrev_b32 v4, 16, v67
    v_and_b32 v5, 0xffff0000, v67
    v_fmac_f32 v154, v126, v4
    v_fmac_f32 v155, v126, v5
    v_fmac_f32 v162, v127, v4
    v_fmac_f32 v163, v127, v5
    s_waitcnt vmcnt(7)
    v_lshlrev_b32 v4, 16, v48
    v_and_b32 v5, 0xffff0000, v48
    v_fmac_f32 v132, v128, v4
    v_fmac_f32 v133, v128, v5
    v_fmac_f32 v140, v129, v4
    v_fmac_f32 v141, v129, v5
    v_lshlrev_b32 v4, 16, v49
    v_and_b32 v5, 0xffff0000, v49
    v_fmac_f32 v134, v128, v4
    v_fmac_f32 v135, v128, v5
    v_fmac_f32 v142, v129, v4
    v_fmac_f32 v143, v129, v5
    v_lshlrev_b32 v4, 16, v50
    v_and_b32 v5, 0xffff0000, v50
    v_fmac_f32 v136, v128, v4
    v_fmac_f32 v137, v128, v5
    v_fmac_f32 v144, v129, v4
    v_fmac_f32 v145, v129, v5
    v_lshlrev_b32 v4, 16, v51
    v_and_b32 v5, 0xffff0000, v51
    v_fmac_f32 v138, v128, v4
    v_fmac_f32 v139, v128, v5
    v_fmac_f32 v146, v129, v4
    v_fmac_f32 v147, v129, v5
    s_waitcnt vmcnt(6)
    v_lshlrev_b32 v4, 16, v68
    v_and_b32 v5, 0xffff0000, v68
    v_fmac_f32 v148, v128, v4
    v_fmac_f32 v149, v128, v5
    v_fmac_f32 v156, v129, v4
    v_fmac_f32 v157, v129, v5
    v_lshlrev_b32 v4, 16, v69
    v_and_b32 v5, 0xffff0000, v69
    v_fmac_f32 v150, v128, v4
    v_fmac_f32 v151, v128, v5
    v_fmac_f32 v158, v129, v4
    v_fmac_f32 v159, v129, v5
    v_lshlrev_b32 v4, 16, v70
    v_and_b32 v5, 0xffff0000, v70
    v_fmac_f32 v152, v128, v4
    v_fmac_f32 v153, v128, v5
    v_fmac_f32 v160, v129, v4
    v_fmac_f32 v161, v129, v5
    v_lshlrev_b32 v4, 16, v71
    v_and_b32 v5, 0xffff0000, v71
    v_fmac_f32 v154, v128, v4
    v_fmac_f32 v155, v128, v5
    v_fmac_f32 v162, v129, v4
    v_fmac_f32 v163, v129, v5
    v_lshlrev_b32 v24, 8, v29
    v_lshl_add_u32 v24, v28, 5, v24
    ds_write_b128 v24, v[132:135] offset:5120
    ds_write_b128 v24, v[136:139] offset:5136
    ds_write_b128 v24, v[140:143] offset:5184
    ds_write_b128 v24, v[144:147] offset:5200
    ds_write_b128 v24, v[148:151] offset:5248
    ds_write_b128 v24, v[152:155] offset:5264
    ds_write_b128 v24, v[156:159] offset:5312
    ds_write_b128 v24, v[160:163] offset:5328
    s_waitcnt lgkmcnt(0)
    s_barrier
    v_lshlrev_b32 v24, 13, v2
    v_add_u32 v24, v24, v3
    ds_read_b32 v132, v24 offset:5120
    ds_read_b32 v133, v24 offset:5376
    ds_read_b32 v134, v24 offset:5632
    ds_read_b32 v135, v24 offset:5888
    ds_read_b32 v136, v24 offset:6144
    ds_read_b32 v137, v24 offset:6400
    ds_read_b32 v138, v24 offset:6656
    ds_read_b32 v139, v24 offset:6912
    ds_read_b32 v140, v24 offset:7168
    ds_read_b32 v141, v24 offset:7424
    ds_read_b32 v142, v24 offset:7680
    ds_read_b32 v143, v24 offset:7936
    ds_read_b32 v144, v24 offset:8192
    ds_read_b32 v145, v24 offset:8448
    ds_read_b32 v146, v24 offset:8704
    ds_read_b32 v147, v24 offset:8960
    ds_read_b32 v148, v24 offset:9216
    ds_read_b32 v149, v24 offset:9472
    ds_read_b32 v150, v24 offset:9728
    ds_read_b32 v151, v24 offset:9984
    ds_read_b32 v152, v24 offset:10240
    ds_read_b32 v153, v24 offset:10496
    ds_read_b32 v154, v24 offset:10752
    ds_read_b32 v155, v24 offset:11008
    ds_read_b32 v156, v24 offset:11264
    ds_read_b32 v157, v24 offset:11520
    ds_read_b32 v158, v24 offset:11776
    ds_read_b32 v159, v24 offset:12032
    ds_read_b32 v160, v24 offset:12288
    ds_read_b32 v161, v24 offset:12544
    ds_read_b32 v162, v24 offset:12800
    ds_read_b32 v163, v24 offset:13056
    s_waitcnt lgkmcnt(0)
    v_add_f32 v25, v132, v133
    v_add_f32 v25, v25, v134
    v_add_f32 v25, v25, v135
    v_add_f32 v25, v25, v136
    v_add_f32 v25, v25, v137
    v_add_f32 v25, v25, v138
    v_add_f32 v25, v25, v139
    v_add_f32 v25, v25, v140
    v_add_f32 v25, v25, v141
    v_add_f32 v25, v25, v142
    v_add_f32 v25, v25, v143
    v_add_f32 v25, v25, v144
    v_add_f32 v25, v25, v145
    v_add_f32 v25, v25, v146
    v_add_f32 v25, v25, v147
    v_add_f32 v25, v25, v148
    v_add_f32 v25, v25, v149
    v_add_f32 v25, v25, v150
    v_add_f32 v25, v25, v151
    v_add_f32 v25, v25, v152
    v_add_f32 v25, v25, v153
    v_add_f32 v25, v25, v154
    v_add_f32 v25, v25, v155
    v_add_f32 v25, v25, v156
    v_add_f32 v25, v25, v157
    v_add_f32 v25, v25, v158
    v_add_f32 v25, v25, v159
    v_add_f32 v25, v25, v160
    v_add_f32 v25, v25, v161
    v_add_f32 v25, v25, v162
    v_add_f32 v25, v25, v163
    v_lshlrev_b32 v24, 2, v0
    ds_write_b32 v24, v25 offset:37888
    s_waitcnt lgkmcnt(0)
    s_barrier
    v_cmp_gt_u32 vcc, 36, v0
    s_and_saveexec_b64 s[44:45], vcc
    s_cbranch_execz kc_skipg
    v_lshlrev_b32 v24, 2, v0
    ds_read_b32 v132, v24 offset:37888
    ds_read_b32 v136, v24 offset:38016
    ds_read_b32 v133, v24 offset:38144
    ds_read_b32 v137, v24 offset:38272
    ds_read_b32 v134, v24 offset:38400
    ds_read_b32 v138, v24 offset:38528
    ds_read_b32 v135, v24 offset:38656
    ds_read_b32 v139, v24 offset:38784
    s_waitcnt lgkmcnt(0)
    v_add_f32 v25, v132, v133
    v_add_f32 v25, v25, v134
    v_add_f32 v25, v25, v135
    v_add_f32 v26, v136, v137
    v_add_f32 v26, v26, v138
    v_add_f32 v26, v26, v139
    v_cvt_pk_bf16_f32 v25, v25, v25
    v_lshlrev_b32 v25, 16, v25
    v_cvt_pk_bf16_f32 v26, v26, v26
    v_lshlrev_b32 v26, 16, v26
    v_mul_f32 v4, v25, v25
    v_mul_f32 v4, v4, v25
    v_mov_b32 v5, 0x3d372713
    v_fma_f32 v4, v4, v5, v25
    v_mul_f32 v4, 0x40135761, v4
    v_exp_f32 v4, v4
    s_nop 0
    v_add_f32 v4, 1.0, v4
    v_rcp_f32 v4, v4
    s_nop 0
    v_fma_f32 v4, v4, -2.0, 2.0
    v_mul_f32 v4, 0.5, v4
    v_mul_f32 v4, v4, v25
    v_cvt_pk_bf16_f32 v4, v4, v4
    v_lshlrev_b32 v4, 16, v4
    v_mul_f32 v4, v4, v26
    v_cvt_pk_bf16_f32 v4, v4, v4
    v_lshlrev_b32 v4, 16, v4
    v_cmp_gt_u32 vcc, 32, v0
    s_nop 1
    v_cndmask_b32 v4, 0, v4, vcc
    v_and_b32 v5, 15, v0
    v_lshlrev_b32 v5, 3, v5
    v_lshrrev_b32 v24, 4, v0
    v_lshl_add_u32 v5, v24, 2, v5
    v_lshlrev_b32 v24, 2, v0
    v_cndmask_b32 v5, v24, v5, vcc
    ds_write_b32 v5, v4 offset:38912
kc_skipg:
    s_mov_b64 exec, s[44:45]
    s_waitcnt lgkmcnt(0)
    s_barrier
    v_lshlrev_b32 v24, 3, v31
    ds_read_b64 v[120:121], v24 offset:38912
    ds_read_b64 v[122:123], v24 offset:38936
    ds_read_b64 v[124:125], v24 offset:38960
    ds_read_b64 v[126:127], v24 offset:38984
    ds_read_b64 v[128:129], v24 offset:39008
    ds_read_b64 v[130:131], v24 offset:39032
    v_mov_b32 v132, 0
    v_mov_b32 v133, 0
    v_mov_b32 v134, 0
    v_mov_b32 v135, 0
    v_mov_b32 v136, 0
    v_mov_b32 v137, 0
    v_mov_b32 v138, 0
    v_mov_b32 v139, 0
    v_mov_b32 v140, 0
    v_mov_b32 v141, 0
    v_mov_b32 v142, 0
    v_mov_b32 v143, 0
    v_mov_b32 v144, 0
    v_mov_b32 v145, 0
    v_mov_b32 v146, 0
    v_mov_b32 v147, 0
    s_waitcnt lgkmcnt(0)
    s_waitcnt vmcnt(0)
    v_lshlrev_b32 v4, 16, v72
    v_and_b32 v5, 0xffff0000, v72
    v_fmac_f32 v132, v120, v4
    v_fmac_f32 v133, v120, v5
    v_fmac_f32 v140, v121, v4
    v_fmac_f32 v141, v121, v5
    v_lshlrev_b32 v4, 16, v73
    v_and_b32 v5, 0xffff0000, v73
    v_fmac_f32 v134, v120, v4
    v_fmac_f32 v135, v120, v5
    v_fmac_f32 v142, v121, v4
    v_fmac_f32 v143, v121, v5
    v_lshlrev_b32 v4, 16, v74
    v_and_b32 v5, 0xffff0000, v74
    v_fmac_f32 v136, v120, v4
    v_fmac_f32 v137, v120, v5
    v_fmac_f32 v144, v121, v4
    v_fmac_f32 v145, v121, v5
    v_lshlrev_b32 v4, 16, v75
    v_and_b32 v5, 0xffff0000, v75
    v_fmac_f32 v138, v120, v4
    v_fmac_f32 v139, v120, v5
    v_fmac_f32 v146, v121, v4
    v_fmac_f32 v147, v121, v5
    v_lshlrev_b32 v4, 16, v76
    v_and_b32 v5, 0xffff0000, v76
    v_fmac_f32 v132, v122, v4
    v_fmac_f32 v133, v122, v5
    v_fmac_f32 v140, v123, v4
    v_fmac_f32 v141, v123, v5
    v_lshlrev_b32 v4, 16, v77
    v_and_b32 v5, 0xffff0000, v77
    v_fmac_f32 v134, v122, v4
    v_fmac_f32 v135, v122, v5
    v_fmac_f32 v142, v123, v4
    v_fmac_f32 v143, v123, v5
    v_lshlrev_b32 v4, 16, v78
    v_and_b32 v5, 0xffff0000, v78
    v_fmac_f32 v136, v122, v4
    v_fmac_f32 v137, v122, v5
    v_fmac_f32 v144, v123, v4
    v_fmac_f32 v145, v123, v5
    v_lshlrev_b32 v4, 16, v79
    v_and_b32 v5, 0xffff0000, v79
    v_fmac_f32 v138, v122, v4
    v_fmac_f32 v139, v122, v5
    v_fmac_f32 v146, v123, v4
    v_fmac_f32 v147, v123, v5
    v_lshlrev_b32 v4, 16, v80
    v_and_b32 v5, 0xffff0000, v80
    v_fmac_f32 v132, v124, v4
    v_fmac_f32 v133, v124, v5
    v_fmac_f32 v140, v125, v4
    v_fmac_f32 v141, v125, v5
    v_lshlrev_b32 v4, 16, v81
    v_and_b32 v5, 0xffff0000, v81
    v_fmac_f32 v134, v124, v4
    v_fmac_f32 v135, v124, v5
    v_fmac_f32 v142, v125, v4
    v_fmac_f32 v143, v125, v5
    v_lshlrev_b32 v4, 16, v82
    v_and_b32 v5, 0xffff0000, v82
    v_fmac_f32 v136, v124, v4
    v_fmac_f32 v137, v124, v5
    v_fmac_f32 v144, v125, v4
    v_fmac_f32 v145, v125, v5
    v_lshlrev_b32 v4, 16, v83
    v_and_b32 v5, 0xffff0000, v83
    v_fmac_f32 v138, v124, v4
    v_fmac_f32 v139, v124, v5
    v_fmac_f32 v146, v125, v4
    v_fmac_f32 v147, v125, v5
    v_lshlrev_b32 v4, 16, v84
    v_and_b32 v5, 0xffff0000, v84
    v_fmac_f32 v132, v126, v4
    v_fmac_f32 v133, v126, v5
    v_fmac_f32 v140, v127, v4
    v_fmac_f32 v141, v127, v5
    v_lshlrev_b32 v4, 16, v85
    v_and_b32 v5, 0xffff0000, v85
    v_fmac_f32 v134, v126, v4
    v_fmac_f32 v135, v126, v5
    v_fmac_f32 v142, v127, v4
    v_fmac_f32 v143, v127, v5
    v_lshlrev_b32 v4, 16, v86
    v_and_b32 v5, 0xffff0000, v86
    v_fmac_f32 v136, v126, v4
    v_fmac_f32 v137, v126, v5
    v_fmac_f32 v144, v127, v4
    v_fmac_f32 v145, v127, v5
    v_lshlrev_b32 v4, 16, v87
    v_and_b32 v5, 0xffff0000, v87
    v_fmac_f32 v138, v126, v4
    v_fmac_f32 v139, v126, v5
    v_fmac_f32 v146, v127, v4
    v_fmac_f32 v147, v127, v5
    v_lshlrev_b32 v4, 16, v88
    v_and_b32 v5, 0xffff0000, v88
    v_fmac_f32 v132, v128, v4
    v_fmac_f32 v133, v128, v5
    v_fmac_f32 v140, v129, v4
    v_fmac_f32 v141, v129, v5
    v_lshlrev_b32 v4, 16, v89
    v_and_b32 v5, 0xffff0000, v89
    v_fmac_f32 v134, v128, v4
    v_fmac_f32 v135, v128, v5
    v_fmac_f32 v142, v129, v4
    v_fmac_f32 v143, v129, v5
    v_lshlrev_b32 v4, 16, v90
    v_and_b32 v5, 0xffff0000, v90
    v_fmac_f32 v136, v128, v4
    v_fmac_f32 v137, v128, v5
    v_fmac_f32 v144, v129, v4
    v_fmac_f32 v145, v129, v5
    v_lshlrev_b32 v4, 16, v91
    v_and_b32 v5, 0xffff0000, v91
    v_fmac_f32 v138, v128, v4
    v_fmac_f32 v139, v128, v5
    v_fmac_f32 v146, v129, v4
    v_fmac_f32 v147, v129, v5
    v_lshlrev_b32 v4, 16, v92
    v_and_b32 v5, 0xffff0000, v92
    v_fmac_f32 v132, v130, v4
    v_fmac_f32 v133, v130, v5
    v_fmac_f32 v140, v131, v4
    v_fmac_f32 v141, v131, v5
    v_lshlrev_b32 v4, 16, v93
    v_and_b32 v5, 0xffff0000, v93
    v_fmac_f32 v134, v130, v4
    v_fmac_f32 v135, v130, v5
    v_fmac_f32 v142, v131, v4
    v_fmac_f32 v143, v131, v5
    v_lshlrev_b32 v4, 16, v94
    v_and_b32 v5, 0xffff0000, v94
    v_fmac_f32 v136, v130, v4
    v_fmac_f32 v137, v130, v5
    v_fmac_f32 v144, v131, v4
    v_fmac_f32 v145, v131, v5
    v_lshlrev_b32 v4, 16, v95
    v_and_b32 v5, 0xffff0000, v95
    v_fmac_f32 v138, v130, v4
    v_fmac_f32 v139, v130, v5
    v_fmac_f32 v146, v131, v4
    v_fmac_f32 v147, v131, v5
    v_mul_u32_u24 v24, 5120, v31
    v_lshl_add_u32 v24, v98, 5, v24
    v_cmp_gt_u32 vcc, 240, v0
    s_and_saveexec_b64 s[44:45], vcc
    ds_write_b128 v24, v[132:135] offset:5120
    ds_write_b128 v24, v[136:139] offset:5136
    ds_write_b128 v24, v[140:143] offset:7680
    ds_write_b128 v24, v[144:147] offset:7696
    s_mov_b64 exec, s[44:45]
    s_waitcnt lgkmcnt(0)
    s_barrier
    v_lshlrev_b32 v24, 2, v0
    ds_read_b32 v132, v24 offset:5120
    ds_read_b32 v133, v24 offset:10240
    ds_read_b32 v134, v24 offset:15360
    ds_read_b32 v135, v24 offset:6144
    ds_read_b32 v136, v24 offset:11264
    ds_read_b32 v137, v24 offset:16384
    ds_read_b32 v138, v24 offset:7168
    ds_read_b32 v139, v24 offset:12288
    ds_read_b32 v140, v24 offset:17408
    ds_read_b32 v141, v24 offset:8192
    ds_read_b32 v142, v24 offset:13312
    ds_read_b32 v143, v24 offset:18432
    ds_read_b32 v144, v24 offset:9216
    ds_read_b32 v145, v24 offset:14336
    ds_read_b32 v146, v24 offset:19456
    s_waitcnt lgkmcnt(0)
    s_mul_i32 s42, s40, 5120
    s_add_u32 s42, s42, 1094656
    v_add_f32 v132, v132, v133
    v_add_f32 v132, v132, v134
    buffer_store_dword v132, v24, s[16:19], s42 offen offset:0 sc1
    v_add_f32 v135, v135, v136
    v_add_f32 v135, v135, v137
    buffer_store_dword v135, v24, s[16:19], s42 offen offset:1024 sc1
    v_add_f32 v138, v138, v139
    v_add_f32 v138, v138, v140
    buffer_store_dword v138, v24, s[16:19], s42 offen offset:2048 sc1
    v_add_f32 v141, v141, v142
    v_add_f32 v141, v141, v143
    buffer_store_dword v141, v24, s[16:19], s42 offen offset:3072 sc1
    v_add_f32 v144, v144, v145
    v_add_f32 v144, v144, v146
    s_add_u32 s42, s42, 4096
    buffer_store_dword v144, v24, s[16:19], s42 offen offset:0 sc1
    s_endpgm
kt_role_d:
    s_sub_u32 s2, s2, 256
    s_load_dwordx2 s[16:17], s[0:1], 88
    s_load_dwordx2 s[28:29], s[0:1], 72
    s_load_dwordx2 s[60:61], s[0:1], 80
    s_waitcnt lgkmcnt(0)
    s_and_b32 s17, s17, 0xffff
    s_mov_b32 s18, 805306368
    s_mov_b32 s19, 0x00020000
    s_and_b32 s29, s29, 0xffff
    s_mov_b32 s30, 2560
    s_mov_b32 s31, 0x00020000
    s_and_b32 s61, s61, 0xffff
    s_mov_b32 s62, 256
    s_mov_b32 s63, 0x00020000
    v_and_b32 v1, 63, v0
    v_lshrrev_b32 v2, 6, v0
    v_lshlrev_b32 v3, 2, v1
    s_mov_b32 s58, 0
    s_movk_i32 s20, 5120
    v_mul_lo_u32 v6, v2, s20
    v_mul_u32_u24 v6, 24, v6
    v_add_u32 v6, v6, v3
    s_lshl_b32 s21, s2, 8
kd_poll:
    s_add_u32 s22, s21, 1094656
    buffer_load_dword v16, v6, s[16:19], s22 offen sc1
    s_add_u32 s22, s22, 5120
    buffer_load_dword v17, v6, s[16:19], s22 offen sc1
    s_add_u32 s22, s22, 5120
    buffer_load_dword v18, v6, s[16:19], s22 offen sc1
    s_add_u32 s22, s22, 5120
    buffer_load_dword v19, v6, s[16:19], s22 offen sc1
    s_add_u32 s22, s22, 5120
    buffer_load_dword v20, v6, s[16:19], s22 offen sc1
    s_add_u32 s22, s22, 5120
    buffer_load_dword v21, v6, s[16:19], s22 offen sc1
    s_add_u32 s22, s22, 5120
    buffer_load_dword v22, v6, s[16:19], s22 offen sc1
    s_add_u32 s22, s22, 5120
    buffer_load_dword v23, v6, s[16:19], s22 offen sc1
    s_add_u32 s22, s22, 5120
    buffer_load_dword v24, v6, s[16:19], s22 offen sc1
    s_add_u32 s22, s22, 5120
    buffer_load_dword v25, v6, s[16:19], s22 offen sc1
    s_add_u32 s22, s22, 5120
    buffer_load_dword v26, v6, s[16:19], s22 offen sc1
    s_add_u32 s22, s22, 5120
    buffer_load_dword v27, v6, s[16:19], s22 offen sc1
    s_add_u32 s22, s22, 5120
    buffer_load_dword v28, v6, s[16:19], s22 offen sc1
    s_add_u32 s22, s22, 5120
    buffer_load_dword v29, v6, s[16:19], s22 offen sc1
    s_add_u32 s22, s22, 5120
    buffer_load_dword v30, v6, s[16:19], s22 offen sc1
    s_add_u32 s22, s22, 5120
    buffer_load_dword v31, v6, s[16:19], s22 offen sc1
    s_add_u32 s22, s22, 5120
    buffer_load_dword v32, v6, s[16:19], s22 offen sc1
    s_add_u32 s22, s22, 5120
    buffer_load_dword v33, v6, s[16:19], s22 offen sc1
    s_add_u32 s22, s22, 5120
    buffer_load_dword v34, v6, s[16:19], s22 offen sc1
    s_add_u32 s22, s22, 5120
    buffer_load_dword v35, v6, s[16:19], s22 offen sc1
    s_add_u32 s22, s22, 5120
    buffer_load_dword v36, v6, s[16:19], s22 offen sc1
    s_add_u32 s22, s22, 5120
    buffer_load_dword v37, v6, s[16:19], s22 offen sc1
    s_add_u32 s22, s22, 5120
    buffer_load_dword v38, v6, s[16:19], s22 offen sc1
    s_add_u32 s22, s22, 5120
    buffer_load_dword v39, v6, s[16:19], s22 offen sc1
    s_add_u32 s22, s21, 1089536
    buffer_load_dword v8, v3, s[16:19], s22 offen sc1
    s_waitcnt vmcnt(0)
    v_max_u32 v40, v8, v16
    v_max_u32 v40, v40, v17
    v_max3_u32 v40, v40, v18, v19
    v_max3_u32 v40, v40, v20, v21
    v_max3_u32 v40, v40, v22, v23
    v_max3_u32 v40, v40, v24, v25
    v_max3_u32 v40, v40, v26, v27
    v_max3_u32 v40, v40, v28, v29
    v_max3_u32 v40, v40, v30, v31
    v_max3_u32 v40, v40, v32, v33
    v_max3_u32 v40, v40, v34, v35
    v_max3_u32 v40, v40, v36, v37
    v_max3_u32 v40, v40, v38, v39
    v_cmp_eq_u32 vcc, -1, v40
    s_add_u32 s58, s58, 1
    s_nop 1
    s_cbranch_vccz kd_poll_ok
    s_sleep 1
    s_cmp_lt_u32 s58, 0x10000
    s_cbranch_scc1 kd_poll
kd_poll_ok:
    v_add_f32 v9, v16, v17
    v_add_f32 v9, v9, v18
    v_add_f32 v9, v9, v19
    v_add_f32 v9, v9, v20
    v_add_f32 v9, v9, v21
    v_add_f32 v9, v9, v22
    v_add_f32 v9, v9, v23
    v_add_f32 v9, v9, v24
    v_add_f32 v9, v9, v25
    v_add_f32 v9, v9, v26
    v_add_f32 v9, v9, v27
    v_add_f32 v9, v9, v28
    v_add_f32 v9, v9, v29
    v_add_f32 v9, v9, v30
    v_add_f32 v9, v9, v31
    v_add_f32 v9, v9, v32
    v_add_f32 v9, v9, v33
    v_add_f32 v9, v9, v34
    v_add_f32 v9, v9, v35
    v_add_f32 v9, v9, v36
    v_add_f32 v9, v9, v37
    v_add_f32 v9, v9, v38
    v_add_f32 v9, v9, v39
    v_lshlrev_b32 v10, 2, v0
    ds_write_b32 v10, v9
    s_waitcnt lgkmcnt(0)
    s_barrier
    v_cmp_gt_u32 vcc, 64, v0
    s_and_saveexec_b64 s[22:23], vcc
    s_cbranch_execz kt_done
    ds_read_b32 v16, v3 offset:0
    ds_read_b32 v17, v3 offset:256
    ds_read_b32 v18, v3 offset:512
    ds_read_b32 v19, v3 offset:768
    s_waitcnt lgkmcnt(0) vmcnt(0)
    v_add_f32 v9, v16, v17
    v_add_f32 v9, v9, v18
    v_add_f32 v9, v9, v19
    v_cvt_pk_bf16_f32 v9, v9, v9
    v_lshlrev_b32 v9, 16, v9
    v_add_f32 v9, v9, v8
    v_cvt_pk_bf16_f32 v9, v9, v9
    v_lshlrev_b32 v10, 1, v1
    s_lshl_b32 s21, s2, 7
    buffer_store_short v9, v10, s[28:31], s21 offen
    s_endpgm
kt_done:
    s_endpgm
.section .rodata,"a"
.p2align 6
.p2align 6
.amdhsa_kernel kq_kernel
  .amdhsa_next_free_vgpr 104
  .amdhsa_next_free_sgpr 96
  .amdhsa_accum_offset 104
  .amdhsa_group_segment_fixed_size 0
  .amdhsa_kernarg_size 96
  .amdhsa_user_sgpr_count 2
  .amdhsa_user_sgpr_kernarg_segment_ptr 1
  .amdhsa_system_sgpr_workgroup_id_x 1
.end_amdhsa_kernel
.p2align 6
.amdhsa_kernel ka_kernel
  .amdhsa_next_free_vgpr 168
  .amdhsa_next_free_sgpr 96
  .amdhsa_accum_offset 168
  .amdhsa_group_segment_fixed_size 0
  .amdhsa_kernarg_size 96
  .amdhsa_user_sgpr_count 2
  .amdhsa_user_sgpr_kernarg_segment_ptr 1
  .amdhsa_system_sgpr_workgroup_id_x 1
.end_amdhsa_kernel
.p2align 6
.amdhsa_kernel kt_kernel
  .amdhsa_next_free_vgpr 244
  .amdhsa_next_free_sgpr 96
  .amdhsa_accum_offset 244
  .amdhsa_group_segment_fixed_size 0
  .amdhsa_kernarg_size 96
  .amdhsa_user_sgpr_count 2
  .amdhsa_user_sgpr_kernarg_segment_ptr 1
  .amdhsa_system_sgpr_workgroup_id_x 1
.end_amdhsa_kernel
```
